```python
import torch

def _softmax(x, axis=-1):
    return torch.softmax(x, dim=axis)
def _gelu(x):
    return torch.nn.functional.gelu(x, approximate="tanh")
def _silu(x):
    return torch.nn.functional.silu(x)
def _sigmoid(x):
    return torch.sigmoid(x)
def _layernorm(x, axis=-1, eps=1e-5):
    m = x.mean(dim=axis, keepdim=True)
    v = x.var(dim=axis, keepdim=True, unbiased=False)
    return (x - m) / torch.sqrt(v + eps)
def _scatter_add(tgt, idx, src, axis=0):
    return tgt.clone().index_add_(axis, idx, src)
def _segment_sum(src, seg, n):
    out = torch.zeros((n,) + src.shape[1:], dtype=src.dtype)
    return out.index_add_(0, seg, src)
def _pad(x, pw):
    flat = tuple(v for pair in reversed(pw) for v in pair)
    return torch.nn.functional.pad(x, flat)

kernel_name = 'gated_mix__ssm_conv_s4d__ssm_conv_s5__prompt'

def setup_inputs():

    _w = (lambda a: (lambda t: t.to(torch.bfloat16) if t.is_floating_point() else t)(torch.as_tensor(a)))
    def _A_setup():
        Bsz, L, D, N = 1, 2048, 512, 128
        return {
            "u": _w((lambda *s: torch.randn(*s, dtype=torch.bfloat16) * 0.05)(Bsz, L, D)),
            "log_A_real": _w((lambda *s: torch.randn(*s, dtype=torch.bfloat16) * 3.2)(D, N) * 0.5),
            "A_imag": _w((lambda *s: torch.randn(*s, dtype=torch.bfloat16) * 0.05)(D, N) * 3.14),
            "C_real": _w((lambda *s: torch.randn(*s, dtype=torch.bfloat16) * 0.1)(D, N) / N ** 0.5),
            "C_imag": _w((lambda *s: torch.randn(*s, dtype=torch.bfloat16) * 0.1)(D, N) / N ** 0.5),
            "log_dt": _w((lambda *s: torch.randn(*s, dtype=torch.bfloat16) * 0.05)(D) * 0.5 - 4.0),
            "D_skip": _w((lambda *s: torch.randn(*s, dtype=torch.bfloat16) * 0.05)(D)),
        }
    _A_in = _A_setup()

    def _B_setup():
        B, S, D = 1, 2048, 512
        P = D
        Lambda_re = -0.5 * (lambda _x: torch.exp(torch.as_tensor(_x)))((lambda *s: torch.randn(*s, dtype=torch.bfloat16) * 0.2)(P))
        Lambda_im = (lambda *s: torch.randn(*s, dtype=torch.bfloat16) * 0.4)(P) * 1.0
        B_re = (lambda *s: torch.randn(*s, dtype=torch.bfloat16) * 0.2)(P, D) * (D ** -0.5)
        B_im = (lambda *s: torch.randn(*s, dtype=torch.bfloat16) * 0.2)(P, D) * (D ** -0.5)
        C_re = (lambda *s: torch.randn(*s, dtype=torch.bfloat16) * 0.2)(D, P) * (P ** -0.5)
        C_im = (lambda *s: torch.randn(*s, dtype=torch.bfloat16) * 0.2)(D, P) * (P ** -0.5)
        log_dt = (lambda *s: torch.randn(*s, dtype=torch.bfloat16) * 0.2)(P) * 0.3 - 2.0
        Dskip = (lambda *s: torch.randn(*s, dtype=torch.bfloat16) * 0.05)(D)
        return {
            "x": _w((lambda *s: torch.randn(*s, dtype=torch.bfloat16) * 0.05)(B, S, D)),
            "Lambda_re": _w(Lambda_re),
            "Lambda_im": _w(Lambda_im),
            "B_re": _w(B_re),
            "B_im": _w(B_im),
            "C_re": _w(C_re),
            "C_im": _w(C_im),
            "log_dt": _w(log_dt),
            "Dskip": _w(Dskip),
        }
    _B_in = _B_setup()

    return {
        "A_u": _A_in["u"],
        "A_log_A_real": _A_in["log_A_real"],
        "A_A_imag": _A_in["A_imag"],
        "A_C_real": _A_in["C_real"],
        "A_C_imag": _A_in["C_imag"],
        "A_log_dt": _A_in["log_dt"],
        "A_D_skip": _A_in["D_skip"],
        "B_x": _B_in["x"],
        "B_Lambda_re": _B_in["Lambda_re"],
        "B_Lambda_im": _B_in["Lambda_im"],
        "B_B_re": _B_in["B_re"],
        "B_B_im": _B_in["B_im"],
        "B_C_re": _B_in["C_re"],
        "B_C_im": _B_in["C_im"],
        "B_log_dt": _B_in["log_dt"],
        "B_Dskip": _B_in["Dskip"],
        "gate_w": _w((lambda *s: torch.randn(*s, dtype=torch.bfloat16) * 0.05)(512) * 16.0),
    }

def reference(A_u, A_log_A_real, A_A_imag, A_C_real, A_C_imag, A_log_dt, A_D_skip, B_x, B_Lambda_re, B_Lambda_im, B_B_re, B_B_im, B_C_re, B_C_im, B_log_dt, B_Dskip, gate_w):
    def _A_ref(u, log_A_real, A_imag, C_real, C_imag, log_dt, D_skip):
        L = u.shape[1]
        dt = torch.exp(log_dt)
        A = -torch.exp(log_A_real) + 1j * A_imag
        C = (C_real + 1j * C_imag) * dt[:, None]
        pos = (lambda x, dt: x.to(dt))(torch.arange(L), log_dt.dtype)
        P = torch.exp((A * dt[:, None])[:, :, None] * pos[None, None, :])
        K = 2.0 * torch.einsum("dn,dnl->dl", C, P).real
        L2 = 2 * L
        u_t = (lambda x, *d: x.permute(*d))(u, 0, 2, 1)
        Kf = (lambda x, *a, **k: torch.fft.rfft(x.float(), *a, **k))(K, L2)
        Uf = (lambda x, *a, **k: torch.fft.rfft(x.float(), *a, **k))(u_t, L2)
        y = (lambda x, *a, **k: torch.fft.irfft(x, *a, **k).to(torch.bfloat16))(Uf * Kf[None, :, :], L2)[:, :, :L]
        y = (lambda x, *d: x.permute(*d))(y, 0, 2, 1)
        return y + u * D_skip[None, None, :]

    def _B_ref(x, Lambda_re, Lambda_im, B_re, B_im, C_re, C_im, log_dt, Dskip):
        Bsz, L, H = x.shape
        Lam = Lambda_re + 1j * Lambda_im
        Bmat = B_re + 1j * B_im
        Cmat = C_re + 1j * C_im
        dt = torch.exp(log_dt)
        Lam_bar = torch.exp(dt * Lam)
        B_bar = ((Lam_bar - 1.0) / Lam)[:, None] * Bmat
        Bu = torch.einsum("bld,pd->blp", x + 0j, B_bar)
        h = torch.zeros_like(Bu[:, 0, :])
        hs = []
        for t in range(L):
            h = Lam_bar[None, :] * h + Bu[:, t, :]
            hs.append(h)
        hseq = torch.stack(hs, 1)
        y = 2.0 * torch.einsum("blp,dp->bld", hseq, Cmat).real + x * Dskip[None, None, :]
        return y

    x = A_u
    g = _sigmoid((x * gate_w).sum(-1, keepdims=True))
    a = _A_ref(x, A_log_A_real, A_A_imag, A_C_real, A_C_imag, A_log_dt, A_D_skip)
    b = _B_ref(x, B_Lambda_re, B_Lambda_im, B_B_re, B_B_im, B_C_re, B_C_im, B_log_dt, B_Dskip)
    return g * a + (1 - g) * b
```

```asm
; @launch grid=(512,1,1) block=(256,1,1) lds=73728
.amdgcn_target "amdgcn-amd-amdhsa--gfx950"
.text
.globl gated_mix__ssm_conv_s4d__ssm_conv_s5__prompt_kernel
.p2align 8
.type gated_mix__ssm_conv_s4d__ssm_conv_s5__prompt_kernel,@function
gated_mix__ssm_conv_s4d__ssm_conv_s5__prompt_kernel:
    s_cmp_ge_u32 s2, 512
    s_cbranch_scc0 K1_GO
    s_endpgm
K1_GO:
    s_load_dwordx16 s[16:31], s[0:1], 0
    s_load_dwordx16 s[32:47], s[0:1], 64
    s_load_dwordx8 s[48:55], s[0:1], 128
    s_memrealtime s[96:97]
    v_lshrrev_b32 v4, 6, v0
    v_and_b32 v1, 63, v0
    v_readfirstlane_b32 s3, v4
    v_lshrrev_b32 v2, 5, v1
    v_and_b32 v3, 31, v1
    v_bfe_u32 v4, v1, 1, 1
    v_bfe_u32 v5, v1, 3, 2
    v_lshl_or_b32 v4, v5, 1, v4
    v_lshrrev_b32 v5, 2, v1
    v_lshrrev_b32 v6, 3, v1
    v_xor_b32 v5, v5, v6
    v_lshrrev_b32 v6, 4, v1
    v_xor_b32 v5, v5, v6
    v_and_b32 v5, 1, v5
    s_cmp_ge_u32 s2, 256
    s_cbranch_scc1 K1_GEMM
K1_CONV:
    s_setprio 3
    s_and_b32 s4, s2, 7
    s_lshl_b32 s4, s4, 5
    s_bfe_u32 s8, s2, 0x50003
    s_add_u32 s4, s4, s8
    s_lshr_b32 s6, s3, 1
    s_and_b32 s7, s3, 1
    s_lshl_b32 s5, s4, 1
    s_add_u32 s5, s5, s6
    s_lshl_b32 s8, s4, 9
    v_lshl_add_u32 v6, v0, 1, s8
    s_lshl_b32 s8, s5, 1
    v_mov_b32 v7, s8
    s_and_b32 s8, s4, 31
    s_lshl_b32 s8, s8, 16
    s_lshr_b32 s9, s4, 5
    s_lshl_b32 s9, s9, 7
    s_add_u32 s13, s8, s9
    v_lshrrev_b32 v9, 5, v0
    v_lshlrev_b32 v8, 11, v3
    v_lshl_add_u32 v8, v9, 4, v8
    s_waitcnt lgkmcnt(0)
    s_mov_b32 s88, s52
    s_mov_b32 s89, s53
    s_mov_b32 s90, 256
    s_mov_b32 s91, 0x20000
    s_or_b32 s8, s2, s3
    s_cmp_lg_u32 s8, 0
    s_cbranch_scc1 G_NW
    s_or_b32 s99, s96, 1
    v_mov_b32 v14, s99
    v_lshlrev_b32 v15, 24, v1
    buffer_store_dword v14, v15, s[88:91], 0 offen sc1
G_NW:
    s_mov_b32 s56, s18
    s_mov_b32 s57, s19
    s_mov_b32 s58, 131072
    s_mov_b32 s59, 0x20000
    buffer_load_ushort v20, v6, s[56:59], 0 offen
    s_mov_b32 s60, s20
    s_mov_b32 s61, s21
    s_mov_b32 s62, 131072
    s_mov_b32 s63, 0x20000
    buffer_load_ushort v21, v6, s[60:63], 0 offen
    s_mov_b32 s64, s22
    s_mov_b32 s65, s23
    s_mov_b32 s66, 131072
    s_mov_b32 s67, 0x20000
    buffer_load_ushort v22, v6, s[64:67], 0 offen
    s_mov_b32 s68, s24
    s_mov_b32 s69, s25
    s_mov_b32 s70, 131072
    s_mov_b32 s71, 0x20000
    buffer_load_ushort v23, v6, s[68:71], 0 offen
    s_mov_b32 s72, s26
    s_mov_b32 s73, s27
    s_mov_b32 s74, 1024
    s_mov_b32 s75, 0x20000
    buffer_load_ushort v24, v7, s[72:75], 0 offen
    s_mov_b32 s76, s16
    s_mov_b32 s77, s17
    s_mov_b32 s78, 2097152
    s_mov_b32 s79, 0x20000
    buffer_load_dwordx4 v[200:203], v8, s[76:79], s13 offen
    buffer_load_dwordx4 v[204:207], v8, s[76:79], s13 offen offset:1024
    s_mov_b32 s92, s54
    s_mov_b32 s93, s55
    s_mov_b32 s94, 16777216
    s_mov_b32 s95, 0x20000
    s_setprio 0
    s_andn2_b32 s8, s4, 31
    s_lshl_b32 s8, s8, 14
    s_and_b32 s9, s4, 31
    s_lshl_b32 s9, s9, 9
    s_add_u32 s13, s8, s9
    s_add_u32 s13, s13, 10485760
    v_lshlrev_b32 v8, 16, v9
    v_lshl_add_u32 v8, v3, 4, v8
    s_mov_b32 s14, 0x05040100
    s_mov_b32 s15, 0x07060302
    v_add_u32 v14, 0, v0
    v_lshrrev_b32 v15, 6, v14
    v_and_b32 v14, 63, v14
    v_mul_u32_u24 v15, 2208, v15
    v_lshl_add_u32 v10, v14, 2, v15
    v_add_u32 v14, 1, v0
    v_lshrrev_b32 v15, 6, v14
    v_and_b32 v14, 63, v14
    v_mul_u32_u24 v15, 2208, v15
    v_lshl_add_u32 v11, v14, 2, v15
    v_add_u32 v14, 2, v0
    v_lshrrev_b32 v15, 6, v14
    v_and_b32 v14, 63, v14
    v_mul_u32_u24 v15, 2208, v15
    v_lshl_add_u32 v12, v14, 2, v15
    v_add_u32 v14, 3, v0
    v_lshrrev_b32 v15, 6, v14
    v_and_b32 v14, 63, v14
    v_mul_u32_u24 v15, 2208, v15
    v_lshl_add_u32 v13, v14, 2, v15
    v_lshrrev_b32 v14, 2, v3
    v_and_b32 v15, 3, v3
    v_and_b32 v16, 3, v14
    v_mul_u32_u24 v14, 272, v14
    v_lshl_add_u32 v14, v15, 2, v14
    v_cmp_lt_u32 vcc, v15, v16
    v_mov_b32 v224, 0
    v_mov_b32 v225, 0
    v_mov_b32 v226, 0
    v_mov_b32 v227, 0
    s_and_saveexec_b64 s[10:11], vcc
    ds_write_b32 v14, v224 offset:34816
    s_mov_b64 exec, s[10:11]
    s_mul_i32 s12, s3, 8704
    v_lshl_add_u32 v16, v1, 2, s12
    v_mul_u32_u24 v17, 272, v3
    v_lshl_add_u32 v17, v2, 4, v17
    v_add_u32 v17, s12, v17
    s_waitcnt vmcnt(2)
    s_mov_b32 m0, s12
    v_lshlrev_b32 v20, 16, v20
    v_lshlrev_b32 v21, 16, v21
    v_lshlrev_b32 v22, 16, v22
    v_lshlrev_b32 v23, 16, v23
    v_lshlrev_b32 v24, 16, v24
    v_mul_f32 v24, 0x3fb8aa3b, v24
    v_exp_f32 v24, v24
    s_nop 0
    v_cvt_pk_bf16_f32 v24, v24, v24
    v_and_b32 v24, 0xffff0000, v24
    v_mul_f32 v20, 0x3fb8aa3b, v20
    v_exp_f32 v20, v20
    s_nop 0
    v_cvt_pk_bf16_f32 v20, v20, v20
    v_and_b32 v20, 0xffff0000, v20
    v_mul_f32 v20, v20, v24
    v_mul_f32 v21, v21, v24
    v_mul_f32 v20, 0xbfb8aa3b, v20
    v_mul_f32 v21, 0x3e22f983, v21
    v_add_f32 v24, v24, v24
    v_mul_f32 v22, v22, v24
    v_mul_f32 v23, v23, v24
    v_mul_f32 v18, 0x41000000, v20
    v_mul_f32 v19, 0x41000000, v21
    v_exp_f32 v18, v18
    v_fract_f32 v19, v19
    v_cos_f32 v26, v19
    v_sin_f32 v27, v19
    s_nop 0
    v_mul_f32 v26, v18, v26
    v_mul_f32 v27, v18, v27
    v_mul_f32 v18, 0x41800000, v20
    v_mul_f32 v19, 0x41800000, v21
    v_exp_f32 v18, v18
    v_fract_f32 v19, v19
    v_cos_f32 v28, v19
    v_sin_f32 v29, v19
    s_nop 0
    v_mul_f32 v28, v18, v28
    v_mul_f32 v29, v18, v29
    s_mov_b32 s80, s40
    s_mov_b32 s81, s41
    s_mov_b32 s82, 524288
    s_mov_b32 s83, 0x20000
    s_mov_b32 s84, s42
    s_mov_b32 s85, s43
    s_mov_b32 s86, 524288
    s_mov_b32 s87, 0x20000
    s_mov_b32 s72, s48
    s_mov_b32 s73, s49
    s_mov_b32 s74, 1024
    s_mov_b32 s75, 0x20000
    s_lshr_b32 s8, s4, 4
    s_lshl_b32 s8, s8, 15
    s_and_b32 s9, s4, 15
    s_lshl_b32 s9, s9, 6
    s_add_u32 s8, s8, s9
    s_lshl_b32 s9, s3, 4
    s_add_u32 s8, s8, s9
    v_lshlrev_b32 v14, 10, v3
    v_lshl_add_u32 v14, v2, 3, v14
    buffer_load_dwordx2 v[208:209], v14, s[80:83], s8 offen
    buffer_load_dwordx2 v[210:211], v14, s[84:87], s8 offen
    s_lshl_b32 s8, s4, 13
    s_lshl_b32 s9, s3, 11
    s_add_u32 s8, s8, s9
    v_lshlrev_b32 v14, 4, v1
    buffer_load_dwordx4 v[212:215], v14, s[76:79], s8 offen
    buffer_load_dwordx4 v[216:219], v14, s[76:79], s8 offen offset:1024
    buffer_load_dwordx4 v[220:223], v14, s[72:75], 0 offen
    v_lshlrev_b32 v9, 4, v0
    v_mov_b32 v60, 0x3f80
    ds_write_addtid_b32 v60
    v_cvt_pk_bf16_f32 v61, v26, v27
    ds_write_addtid_b32 v61 offset:272
    v_cvt_pk_bf16_f32 v62, v28, v29
    ds_write_addtid_b32 v62 offset:544
    v_mul_f32 v42, v26, v28
    v_mul_f32 v43, v26, v29
    v_fma_f32 v42, v27, -v29, v42
    v_fmac_f32 v43, v27, v28
    v_cvt_pk_bf16_f32 v63, v42, v43
    ds_write_addtid_b32 v63 offset:816
    v_mul_f32 v44, v28, v28
    v_mul_f32 v45, v28, v29
    v_fma_f32 v44, v29, -v29, v44
    v_fmac_f32 v45, v29, v28
    v_cvt_pk_bf16_f32 v60, v44, v45
    ds_write_addtid_b32 v60 offset:1088
    v_mul_f32 v40, v42, v28
    v_mul_f32 v41, v42, v29
    v_fma_f32 v40, v43, -v29, v40
    v_fmac_f32 v41, v43, v28
    v_cvt_pk_bf16_f32 v61, v40, v41
    ds_write_addtid_b32 v61 offset:1360
    v_mul_f32 v46, v44, v28
    v_mul_f32 v47, v44, v29
    v_fma_f32 v46, v45, -v29, v46
    v_fmac_f32 v47, v45, v28
    v_cvt_pk_bf16_f32 v62, v46, v47
    ds_write_addtid_b32 v62 offset:1632
    v_mul_f32 v42, v40, v28
    v_mul_f32 v43, v40, v29
    v_fma_f32 v42, v41, -v29, v42
    v_fmac_f32 v43, v41, v28
    v_cvt_pk_bf16_f32 v63, v42, v43
    ds_write_addtid_b32 v63 offset:1904
    v_mul_f32 v44, v46, v28
    v_mul_f32 v45, v46, v29
    v_fma_f32 v44, v47, -v29, v44
    v_fmac_f32 v45, v47, v28
    v_cvt_pk_bf16_f32 v60, v44, v45
    ds_write_addtid_b32 v60 offset:2176
    v_mul_f32 v40, v42, v28
    v_mul_f32 v41, v42, v29
    v_fma_f32 v40, v43, -v29, v40
    v_fmac_f32 v41, v43, v28
    v_cvt_pk_bf16_f32 v61, v40, v41
    ds_write_addtid_b32 v61 offset:2448
    v_mul_f32 v46, v44, v28
    v_mul_f32 v47, v44, v29
    v_fma_f32 v46, v45, -v29, v46
    v_fmac_f32 v47, v45, v28
    v_cvt_pk_bf16_f32 v62, v46, v47
    ds_write_addtid_b32 v62 offset:2720
    v_mul_f32 v42, v40, v28
    v_mul_f32 v43, v40, v29
    v_fma_f32 v42, v41, -v29, v42
    v_fmac_f32 v43, v41, v28
    v_cvt_pk_bf16_f32 v63, v42, v43
    ds_write_addtid_b32 v63 offset:2992
    v_mul_f32 v44, v46, v28
    v_mul_f32 v45, v46, v29
    v_fma_f32 v44, v47, -v29, v44
    v_fmac_f32 v45, v47, v28
    v_cvt_pk_bf16_f32 v60, v44, v45
    ds_write_addtid_b32 v60 offset:3264
    v_mul_f32 v40, v42, v28
    v_mul_f32 v41, v42, v29
    v_fma_f32 v40, v43, -v29, v40
    v_fmac_f32 v41, v43, v28
    v_cvt_pk_bf16_f32 v61, v40, v41
    ds_write_addtid_b32 v61 offset:3536
    v_mul_f32 v46, v44, v28
    v_mul_f32 v47, v44, v29
    v_fma_f32 v46, v45, -v29, v46
    v_fmac_f32 v47, v45, v28
    v_cvt_pk_bf16_f32 v62, v46, v47
    ds_write_addtid_b32 v62 offset:3808
    v_mul_f32 v42, v40, v28
    v_mul_f32 v43, v40, v29
    v_fma_f32 v42, v41, -v29, v42
    v_fmac_f32 v43, v41, v28
    v_cvt_pk_bf16_f32 v63, v42, v43
    ds_write_addtid_b32 v63 offset:4080
    v_mul_f32 v44, v46, v28
    v_mul_f32 v45, v46, v29
    v_fma_f32 v44, v47, -v29, v44
    v_fmac_f32 v45, v47, v28
    v_cvt_pk_bf16_f32 v60, v44, v45
    ds_write_addtid_b32 v60 offset:4352
    v_mul_f32 v40, v42, v28
    v_mul_f32 v41, v42, v29
    v_fma_f32 v40, v43, -v29, v40
    v_fmac_f32 v41, v43, v28
    v_cvt_pk_bf16_f32 v61, v40, v41
    ds_write_addtid_b32 v61 offset:4624
    v_mul_f32 v46, v44, v28
    v_mul_f32 v47, v44, v29
    v_fma_f32 v46, v45, -v29, v46
    v_fmac_f32 v47, v45, v28
    v_cvt_pk_bf16_f32 v62, v46, v47
    ds_write_addtid_b32 v62 offset:4896
    v_mul_f32 v42, v40, v28
    v_mul_f32 v43, v40, v29
    v_fma_f32 v42, v41, -v29, v42
    v_fmac_f32 v43, v41, v28
    v_cvt_pk_bf16_f32 v63, v42, v43
    ds_write_addtid_b32 v63 offset:5168
    v_mul_f32 v44, v46, v28
    v_mul_f32 v45, v46, v29
    v_fma_f32 v44, v47, -v29, v44
    v_fmac_f32 v45, v47, v28
    v_cvt_pk_bf16_f32 v60, v44, v45
    ds_write_addtid_b32 v60 offset:5440
    v_mul_f32 v40, v42, v28
    v_mul_f32 v41, v42, v29
    v_fma_f32 v40, v43, -v29, v40
    v_fmac_f32 v41, v43, v28
    v_cvt_pk_bf16_f32 v61, v40, v41
    ds_write_addtid_b32 v61 offset:5712
    v_mul_f32 v46, v44, v28
    v_mul_f32 v47, v44, v29
    v_fma_f32 v46, v45, -v29, v46
    v_fmac_f32 v47, v45, v28
    v_cvt_pk_bf16_f32 v62, v46, v47
    ds_write_addtid_b32 v62 offset:5984
    v_mul_f32 v42, v40, v28
    v_mul_f32 v43, v40, v29
    v_fma_f32 v42, v41, -v29, v42
    v_fmac_f32 v43, v41, v28
    v_cvt_pk_bf16_f32 v63, v42, v43
    ds_write_addtid_b32 v63 offset:6256
    v_mul_f32 v44, v46, v28
    v_mul_f32 v45, v46, v29
    v_fma_f32 v44, v47, -v29, v44
    v_fmac_f32 v45, v47, v28
    v_cvt_pk_bf16_f32 v60, v44, v45
    ds_write_addtid_b32 v60 offset:6528
    v_mul_f32 v40, v42, v28
    v_mul_f32 v41, v42, v29
    v_fma_f32 v40, v43, -v29, v40
    v_fmac_f32 v41, v43, v28
    v_cvt_pk_bf16_f32 v61, v40, v41
    ds_write_addtid_b32 v61 offset:6800
    v_mul_f32 v46, v44, v28
    v_mul_f32 v47, v44, v29
    v_fma_f32 v46, v45, -v29, v46
    v_fmac_f32 v47, v45, v28
    v_cvt_pk_bf16_f32 v62, v46, v47
    ds_write_addtid_b32 v62 offset:7072
    v_mul_f32 v42, v40, v28
    v_mul_f32 v43, v40, v29
    v_fma_f32 v42, v41, -v29, v42
    v_fmac_f32 v43, v41, v28
    v_cvt_pk_bf16_f32 v63, v42, v43
    ds_write_addtid_b32 v63 offset:7344
    v_mul_f32 v44, v46, v28
    v_mul_f32 v45, v46, v29
    v_fma_f32 v44, v47, -v29, v44
    v_fmac_f32 v45, v47, v28
    v_cvt_pk_bf16_f32 v60, v44, v45
    ds_write_addtid_b32 v60 offset:7616
    v_mul_f32 v40, v42, v28
    v_mul_f32 v41, v42, v29
    v_fma_f32 v40, v43, -v29, v40
    v_fmac_f32 v41, v43, v28
    v_cvt_pk_bf16_f32 v61, v40, v41
    ds_write_addtid_b32 v61 offset:7888
    v_mul_f32 v46, v44, v28
    v_mul_f32 v47, v44, v29
    v_fma_f32 v46, v45, -v29, v46
    v_fmac_f32 v47, v45, v28
    v_cvt_pk_bf16_f32 v62, v46, v47
    ds_write_addtid_b32 v62 offset:8160
    v_mul_f32 v42, v40, v28
    v_mul_f32 v43, v40, v29
    v_fma_f32 v42, v41, -v29, v42
    v_fmac_f32 v43, v41, v28
    v_cvt_pk_bf16_f32 v63, v42, v43
    ds_write_addtid_b32 v63 offset:8432
    v_mov_b32 v25, 0
    buffer_load_dword v25, v25, s[88:91], 0 offen sc1
    ds_read_b128 v[128:131], v17 offset:0
    ds_read_b128 v[132:135], v17 offset:32
    ds_read_b128 v[136:139], v17 offset:64
    ds_read_b128 v[140:143], v17 offset:96
    ds_read_b128 v[144:147], v17 offset:128
    ds_read_b128 v[148:151], v17 offset:160
    ds_read_b128 v[152:155], v17 offset:192
    ds_read_b128 v[156:159], v17 offset:224
    s_lshl_b32 s98, s4, 14
    s_add_u32 s98, s98, 10485760
    s_add_u32 s97, s98, 4096
    v_mul_f32 v18, 1.0, v20
    v_mul_f32 v19, 1.0, v21
    v_exp_f32 v18, v18
    v_fract_f32 v19, v19
    v_cos_f32 v30, v19
    v_sin_f32 v31, v19
    s_nop 0
    v_mul_f32 v30, v18, v30
    v_mul_f32 v31, v18, v31
    v_mul_f32 v18, 2.0, v20
    v_mul_f32 v19, 2.0, v21
    v_exp_f32 v18, v18
    v_fract_f32 v19, v19
    v_cos_f32 v32, v19
    v_sin_f32 v33, v19
    s_nop 0
    v_mul_f32 v32, v18, v32
    v_mul_f32 v33, v18, v33
    v_mul_f32 v18, 4.0, v20
    v_mul_f32 v19, 4.0, v21
    v_exp_f32 v18, v18
    v_fract_f32 v19, v19
    v_cos_f32 v34, v19
    v_sin_f32 v35, v19
    s_nop 0
    v_mul_f32 v34, v18, v34
    v_mul_f32 v35, v18, v35
    v_mul_f32 v18, 0x43800000, v20
    v_mul_f32 v19, 0x43800000, v21
    v_exp_f32 v18, v18
    v_fract_f32 v19, v19
    v_cos_f32 v36, v19
    v_sin_f32 v37, v19
    s_nop 0
    v_mul_f32 v36, v18, v36
    v_mul_f32 v37, v18, v37
    v_mul_f32 v66, v22, v36
    v_mul_f32 v67, v22, v37
    v_fma_f32 v66, v23, -v37, v66
    v_fmac_f32 v67, v23, v36
    v_mul_f32 v68, v66, v36
    v_mul_f32 v69, v66, v37
    v_fma_f32 v68, v67, -v37, v68
    v_fmac_f32 v69, v67, v36
    v_mul_f32 v70, v68, v36
    v_mul_f32 v71, v68, v37
    v_fma_f32 v70, v69, -v37, v70
    v_fmac_f32 v71, v69, v36
    v_mul_f32 v72, v70, v36
    v_mul_f32 v73, v70, v37
    v_fma_f32 v72, v71, -v37, v72
    v_fmac_f32 v73, v71, v36
    v_mul_f32 v74, v72, v36
    v_mul_f32 v75, v72, v37
    v_fma_f32 v74, v73, -v37, v74
    v_fmac_f32 v75, v73, v36
    v_mul_f32 v76, v74, v36
    v_mul_f32 v77, v74, v37
    v_fma_f32 v76, v75, -v37, v76
    v_fmac_f32 v77, v75, v36
    v_mul_f32 v78, v76, v36
    v_mul_f32 v79, v76, v37
    v_fma_f32 v78, v77, -v37, v78
    v_fmac_f32 v79, v77, v36
    s_waitcnt lgkmcnt(0)
    v_cvt_pk_bf16_f32 v60, v22, -v23
    ds_write_addtid_b32 v60 offset:0
    v_mul_f32 v40, v22, v30
    v_mul_f32 v41, v22, v31
    v_fma_f32 v40, v23, -v31, v40
    v_fmac_f32 v41, v23, v30
    v_cvt_pk_bf16_f32 v61, v40, -v41
    ds_write_addtid_b32 v61 offset:272
    v_mul_f32 v44, v22, v32
    v_mul_f32 v45, v22, v33
    v_fma_f32 v44, v23, -v33, v44
    v_fmac_f32 v45, v23, v32
    v_cvt_pk_bf16_f32 v62, v44, -v45
    ds_write_addtid_b32 v62 offset:544
    v_mul_f32 v42, v40, v32
    v_mul_f32 v43, v40, v33
    v_fma_f32 v42, v41, -v33, v42
    v_fmac_f32 v43, v41, v32
    v_cvt_pk_bf16_f32 v63, v42, -v43
    ds_write_addtid_b32 v63 offset:816
    v_mul_f32 v46, v44, v32
    v_mul_f32 v47, v44, v33
    v_fma_f32 v46, v45, -v33, v46
    v_fmac_f32 v47, v45, v32
    v_cvt_pk_bf16_f32 v60, v46, -v47
    ds_write_addtid_b32 v60 offset:2176
    v_mul_f32 v40, v42, v32
    v_mul_f32 v41, v42, v33
    v_fma_f32 v40, v43, -v33, v40
    v_fmac_f32 v41, v43, v32
    v_cvt_pk_bf16_f32 v61, v40, -v41
    ds_write_addtid_b32 v61 offset:2448
    v_mul_f32 v44, v46, v32
    v_mul_f32 v45, v46, v33
    v_fma_f32 v44, v47, -v33, v44
    v_fmac_f32 v45, v47, v32
    v_cvt_pk_bf16_f32 v62, v44, -v45
    ds_write_addtid_b32 v62 offset:2720
    v_mul_f32 v42, v40, v32
    v_mul_f32 v43, v40, v33
    v_fma_f32 v42, v41, -v33, v42
    v_fmac_f32 v43, v41, v32
    v_cvt_pk_bf16_f32 v63, v42, -v43
    ds_write_addtid_b32 v63 offset:2992
    v_cvt_pk_bf16_f32 v60, v66, -v67
    ds_write_addtid_b32 v60 offset:4352
    v_mul_f32 v40, v66, v32
    v_mul_f32 v41, v66, v33
    v_fma_f32 v40, v67, -v33, v40
    v_fmac_f32 v41, v67, v32
    v_cvt_pk_bf16_f32 v61, v40, -v41
    ds_write_addtid_b32 v61 offset:4624
    v_mul_f32 v42, v66, v34
    v_mul_f32 v43, v66, v35
    v_fma_f32 v42, v67, -v35, v42
    v_fmac_f32 v43, v67, v34
    v_cvt_pk_bf16_f32 v62, v42, -v43
    ds_write_addtid_b32 v62 offset:4896
    v_mul_f32 v44, v40, v34
    v_mul_f32 v45, v40, v35
    v_fma_f32 v44, v41, -v35, v44
    v_fmac_f32 v45, v41, v34
    v_cvt_pk_bf16_f32 v63, v44, -v45
    ds_write_addtid_b32 v63 offset:5168
    v_mul_f32 v46, v66, v26
    v_mul_f32 v47, v66, v27
    v_fma_f32 v46, v67, -v27, v46
    v_fmac_f32 v47, v67, v26
    v_cvt_pk_bf16_f32 v60, v46, -v47
    ds_write_addtid_b32 v60 offset:6528
    v_cvt_pk_bf16_f32 v61, v68, -v69
    ds_write_addtid_b32 v61 offset:6800
    v_mul_f32 v40, v68, v34
    v_mul_f32 v41, v68, v35
    v_fma_f32 v40, v69, -v35, v40
    v_fmac_f32 v41, v69, v34
    v_cvt_pk_bf16_f32 v62, v40, -v41
    ds_write_addtid_b32 v62 offset:7072
    v_mul_f32 v42, v68, v26
    v_mul_f32 v43, v68, v27
    v_fma_f32 v42, v69, -v27, v42
    v_fmac_f32 v43, v69, v26
    v_cvt_pk_bf16_f32 v63, v42, -v43
    ds_write_addtid_b32 v63 offset:7344
    v_cvt_pk_bf16_f32 v60, v70, -v71
    ds_write_addtid_b32 v60 offset:1088
    v_mul_f32 v40, v70, v34
    v_mul_f32 v41, v70, v35
    v_fma_f32 v40, v71, -v35, v40
    v_fmac_f32 v41, v71, v34
    v_cvt_pk_bf16_f32 v61, v40, -v41
    ds_write_addtid_b32 v61 offset:1360
    v_mul_f32 v42, v70, v26
    v_mul_f32 v43, v70, v27
    v_fma_f32 v42, v71, -v27, v42
    v_fmac_f32 v43, v71, v26
    v_cvt_pk_bf16_f32 v62, v42, -v43
    ds_write_addtid_b32 v62 offset:1632
    v_cvt_pk_bf16_f32 v63, v72, -v73
    ds_write_addtid_b32 v63 offset:1904
    v_mul_f32 v44, v72, v26
    v_mul_f32 v45, v72, v27
    v_fma_f32 v44, v73, -v27, v44
    v_fmac_f32 v45, v73, v26
    v_cvt_pk_bf16_f32 v60, v44, -v45
    ds_write_addtid_b32 v60 offset:3264
    v_cvt_pk_bf16_f32 v61, v74, -v75
    ds_write_addtid_b32 v61 offset:3536
    v_mul_f32 v46, v74, v26
    v_mul_f32 v47, v74, v27
    v_fma_f32 v46, v75, -v27, v46
    v_fmac_f32 v47, v75, v26
    v_cvt_pk_bf16_f32 v62, v46, -v47
    ds_write_addtid_b32 v62 offset:3808
    v_cvt_pk_bf16_f32 v63, v76, -v77
    ds_write_addtid_b32 v63 offset:4080
    v_mul_f32 v44, v76, v26
    v_mul_f32 v45, v76, v27
    v_fma_f32 v44, v77, -v27, v44
    v_fmac_f32 v45, v77, v26
    v_cvt_pk_bf16_f32 v60, v44, -v45
    ds_write_addtid_b32 v60 offset:5440
    v_cvt_pk_bf16_f32 v61, v78, -v79
    ds_write_addtid_b32 v61 offset:5712
    v_mul_f32 v46, v78, v26
    v_mul_f32 v47, v78, v27
    v_fma_f32 v46, v79, -v27, v46
    v_fmac_f32 v47, v79, v26
    v_cvt_pk_bf16_f32 v62, v46, -v47
    ds_write_addtid_b32 v62 offset:5984
    ds_read_b128 v[160:163], v17 offset:0
    ds_read_b128 v[164:167], v17 offset:32
    ds_read_b128 v[168:171], v17 offset:64
    ds_read_b128 v[172:175], v17 offset:96
    ds_read_b128 v[176:179], v17 offset:128
    ds_read_b128 v[180:183], v17 offset:160
    ds_read_b128 v[184:187], v17 offset:192
    ds_read_b128 v[188:191], v17 offset:224
    s_waitcnt lgkmcnt(7)
    v_mfma_f32_32x32x16_bf16 v[64:79], v[160:163], v[128:131], 0
    s_waitcnt lgkmcnt(6)
    v_mfma_f32_32x32x16_bf16 v[64:79], v[164:167], v[132:135], v[64:79]
    s_waitcnt lgkmcnt(5)
    v_mfma_f32_32x32x16_bf16 v[64:79], v[168:171], v[136:139], v[64:79]
    s_waitcnt lgkmcnt(4)
    v_mfma_f32_32x32x16_bf16 v[64:79], v[172:175], v[140:143], v[64:79]
    s_waitcnt lgkmcnt(3)
    v_mfma_f32_32x32x16_bf16 v[64:79], v[176:179], v[144:147], v[64:79]
    s_waitcnt lgkmcnt(2)
    v_mfma_f32_32x32x16_bf16 v[64:79], v[180:183], v[148:151], v[64:79]
    s_waitcnt lgkmcnt(1)
    v_mfma_f32_32x32x16_bf16 v[64:79], v[184:187], v[152:155], v[64:79]
    s_waitcnt lgkmcnt(0)
    v_mfma_f32_32x32x16_bf16 v[64:79], v[188:191], v[156:159], v[64:79]
    s_waitcnt vmcnt(0)
C_NL:
    v_readfirstlane_b32 s99, v25
    s_cmp_lg_u32 s99, 0
    s_cbranch_scc1 C_NOK
    s_sleep 2
    v_mov_b32 v25, 0
    buffer_load_dword v25, v25, s[88:91], 0 offen sc1
    s_waitcnt vmcnt(0)
    s_branch C_NL
C_NOK:
    v_perm_b32 v228, v204, v200, s14
    v_mov_b32 v229, s99
    v_perm_b32 v230, v204, v200, s15
    v_mov_b32 v231, s99
    buffer_store_dwordx4 v[228:231], v8, s[92:95], s13 offen sc1
    s_add_u32 s13, s13, 16384
    v_perm_b32 v232, v205, v201, s14
    v_mov_b32 v233, s99
    v_perm_b32 v234, v205, v201, s15
    v_mov_b32 v235, s99
    buffer_store_dwordx4 v[232:235], v8, s[92:95], s13 offen sc1
    s_add_u32 s13, s13, 16384
    v_perm_b32 v236, v206, v202, s14
    v_mov_b32 v237, s99
    v_perm_b32 v238, v206, v202, s15
    v_mov_b32 v239, s99
    buffer_store_dwordx4 v[236:239], v8, s[92:95], s13 offen sc1
    s_add_u32 s13, s13, 16384
    v_perm_b32 v240, v207, v203, s14
    v_mov_b32 v241, s99
    v_perm_b32 v242, v207, v203, s15
    v_mov_b32 v243, s99
    buffer_store_dwordx4 v[240:243], v8, s[92:95], s13 offen sc1
    s_add_u32 s13, s13, 16384
    v_perm_b32 v244, v210, v208, s14
    v_perm_b32 v245, v210, v208, s15
    v_perm_b32 v246, v211, v209, s14
    v_perm_b32 v247, v211, v209, s15
    s_lshl_b32 s8, s4, 12
    s_add_u32 s8, s8, 4194304
    v_lshlrev_b32 v9, 4, v0
    buffer_store_dwordx4 v[244:247], v9, s[92:95], s8 offen sc1
    v_add_u32 v8, 8192, v9
    v_lshl_add_u32 v16, v1, 4, s12
    s_xor_b32 s13, s3, 1
    s_mul_i32 s13, s13, 8704
    v_lshl_add_u32 v17, v1, 4, s13
    s_nop 7
    ds_write_b128 v16, v[64:67] offset:0
    ds_write_b128 v16, v[68:71] offset:1024
    ds_write_b128 v16, v[72:75] offset:2048
    ds_write_b128 v16, v[76:79] offset:3072
    s_waitcnt lgkmcnt(0)
    s_barrier
    ds_read_b128 v[80:83], v17 offset:0
    ds_read_b128 v[84:87], v17 offset:1024
    ds_read_b128 v[88:91], v17 offset:2048
    ds_read_b128 v[92:95], v17 offset:3072
    s_waitcnt lgkmcnt(0)
    s_barrier
    v_add_f32 v64, v64, v80
    v_add_f32 v65, v65, v81
    v_add_f32 v66, v66, v82
    v_add_f32 v67, v67, v83
    v_add_f32 v68, v68, v84
    v_add_f32 v69, v69, v85
    v_add_f32 v70, v70, v86
    v_add_f32 v71, v71, v87
    v_add_f32 v72, v72, v88
    v_add_f32 v73, v73, v89
    v_add_f32 v74, v74, v90
    v_add_f32 v75, v75, v91
    v_add_f32 v76, v76, v92
    v_add_f32 v77, v77, v93
    v_add_f32 v78, v78, v94
    v_add_f32 v79, v79, v95
    v_lshlrev_b32 v16, 4, v0
    ds_write_b128 v16, v[224:227] offset:19360
    ds_write_b128 v16, v[224:227] offset:23456
    ds_write_b128 v16, v[224:227] offset:27552
    v_min_u32 v16, 3152, v16
    ds_write_b128 v16, v[224:227] offset:31648
    s_mul_i32 s12, s6, 8960
    s_mul_i32 s13, s7, 4480
    s_add_u32 s13, s13, s12
    v_and_b32 v16, 15, v1
    v_lshl_add_u32 v16, v16, 4, s13
    ds_write_b128 v16, v[224:227] offset:4096
    v_sub_u32 v16, 31, v3
    v_lshl_add_u32 v16, v16, 4, s13
    v_and_b32 v17, 1, v1
    v_cmp_eq_u32 vcc, 1, v17
    s_nop 1
    v_cndmask_b32 v84, v67, v68, vcc
    v_cndmask_b32 v85, v69, v70, vcc
    v_cndmask_b32 v86, v71, v72, vcc
    v_cndmask_b32 v87, v73, v74, vcc
    s_cmp_eq_u32 s7, 0
    s_cbranch_scc1 C_R0
    s_mov_b32 exec_hi, 0
    v_cvt_pk_bf16_f32 v80, v71, v70
    v_cvt_pk_bf16_f32 v81, v69, v68
    v_cvt_pk_bf16_f32 v82, v67, v66
    v_cvt_pk_bf16_f32 v83, v65, v64
    ds_write_b128 v16, v[80:83] offset:3584
    s_nop 0
    v_cvt_pk_bf16_f32 v80, v76, v75
    v_cvt_pk_bf16_f32 v81, v74, v74
    v_cvt_pk_bf16_f32 v82, v74, v73
    v_cvt_pk_bf16_f32 v83, v72, v72
    ds_write_b128 v16, v[80:83] offset:3072
    s_nop 0
    v_cvt_pk_bf16_f32 v80, v79, v79
    v_cvt_pk_bf16_f32 v81, v78, v78
    v_cvt_pk_bf16_f32 v82, v78, v77
    v_cvt_pk_bf16_f32 v83, v77, v77
    ds_write_b128 v16, v[80:83] offset:2560
    s_nop 0
    s_mov_b32 exec_hi, -1
    s_mov_b32 exec_lo, 0
    v_cvt_pk_bf16_f32 v80, v66, v66
    v_cvt_pk_bf16_f32 v81, v65, v65
    v_cvt_pk_bf16_f32 v82, v65, v64
    v_cvt_pk_bf16_f32 v83, v64, v64
    ds_write_b128 v16, v[80:83] offset:2048
    s_nop 0
    v_cvt_pk_bf16_f32 v80, v68, v68
    v_cvt_pk_bf16_f32 v81, v68, v84
    v_cvt_pk_bf16_f32 v82, v67, v67
    v_cvt_pk_bf16_f32 v83, v67, v67
    ds_write_b128 v16, v[80:83] offset:1536
    s_nop 0
    v_cvt_pk_bf16_f32 v80, v70, v70
    v_cvt_pk_bf16_f32 v81, v70, v85
    v_cvt_pk_bf16_f32 v82, v69, v69
    v_cvt_pk_bf16_f32 v83, v69, v69
    ds_write_b128 v16, v[80:83] offset:1024
    s_nop 0
    v_cvt_pk_bf16_f32 v80, v72, v72
    v_cvt_pk_bf16_f32 v81, v72, v86
    v_cvt_pk_bf16_f32 v82, v71, v71
    v_cvt_pk_bf16_f32 v83, v71, v71
    ds_write_b128 v16, v[80:83] offset:512
    s_nop 0
    v_cvt_pk_bf16_f32 v80, v74, v74
    v_cvt_pk_bf16_f32 v81, v74, v87
    v_cvt_pk_bf16_f32 v82, v73, v73
    v_cvt_pk_bf16_f32 v83, v73, v73
    ds_write_b128 v16, v[80:83] offset:0
    s_nop 0
    s_mov_b32 exec_lo, -1
    s_branch C_RD
C_R0:
    s_mov_b32 exec_hi, 0
    v_cvt_pk_bf16_f32 v80, v70, v69
    v_cvt_pk_bf16_f32 v81, v68, v67
    v_cvt_pk_bf16_f32 v82, v66, v65
    v_cvt_pk_bf16_f32 v83, v64, v224
    ds_write_b128 v16, v[80:83] offset:3584
    s_nop 0
    v_cvt_pk_bf16_f32 v80, v75, v74
    v_cvt_pk_bf16_f32 v81, v74, v74
    v_cvt_pk_bf16_f32 v82, v73, v72
    v_cvt_pk_bf16_f32 v83, v72, v72
    ds_write_b128 v16, v[80:83] offset:3072
    s_nop 0
    v_cvt_pk_bf16_f32 v80, v79, v78
    v_cvt_pk_bf16_f32 v81, v78, v78
    v_cvt_pk_bf16_f32 v82, v77, v77
    v_cvt_pk_bf16_f32 v83, v77, v77
    ds_write_b128 v16, v[80:83] offset:2560
    s_nop 0
    v_cvt_pk_bf16_f32 v80, v71, v71
    ds_write_b16 v16, v80 offset:3582
    s_mov_b32 exec_hi, -1
    s_mov_b32 exec_lo, 0
    v_cvt_pk_bf16_f32 v80, v66, v65
    v_cvt_pk_bf16_f32 v81, v65, v65
    v_cvt_pk_bf16_f32 v82, v64, v64
    v_cvt_pk_bf16_f32 v83, v64, v64
    ds_write_b128 v16, v[80:83] offset:2048
    s_nop 0
    v_cvt_pk_bf16_f32 v80, v68, v68
    v_cvt_pk_bf16_f32 v81, v84, v67
    v_cvt_pk_bf16_f32 v82, v67, v67
    v_cvt_pk_bf16_f32 v83, v67, v67
    ds_write_b128 v16, v[80:83] offset:1536
    s_nop 0
    v_cvt_pk_bf16_f32 v80, v70, v70
    v_cvt_pk_bf16_f32 v81, v85, v69
    v_cvt_pk_bf16_f32 v82, v69, v69
    v_cvt_pk_bf16_f32 v83, v69, v69
    ds_write_b128 v16, v[80:83] offset:1024
    s_nop 0
    v_cvt_pk_bf16_f32 v80, v72, v72
    v_cvt_pk_bf16_f32 v81, v86, v71
    v_cvt_pk_bf16_f32 v82, v71, v71
    v_cvt_pk_bf16_f32 v83, v71, v71
    ds_write_b128 v16, v[80:83] offset:512
    s_nop 0
    v_cvt_pk_bf16_f32 v80, v74, v74
    v_cvt_pk_bf16_f32 v81, v87, v73
    v_cvt_pk_bf16_f32 v82, v73, v73
    v_cvt_pk_bf16_f32 v83, v73, v73
    ds_write_b128 v16, v[80:83] offset:0
    s_nop 0
    s_mov_b32 exec_lo, -1
C_RD:
    s_lshl_b32 s8, s4, 9
    s_lshl_b32 s9, s3, 7
    s_add_u32 s8, s8, s9
    s_add_u32 s8, s8, 7864320
    s_waitcnt vmcnt(0)
    v_mov_b32 v18, s99
    v_lshlrev_b32 v19, 24, v1
    buffer_store_dword v18, v19, s[92:95], s8 offen sc1
    buffer_load_dwordx4 v[228:231], v9, s[92:95], s98 offen offset:0 sc1
    buffer_load_dwordx4 v[232:235], v9, s[92:95], s97 offen sc1
    buffer_load_dwordx4 v[236:239], v8, s[92:95], s98 offen offset:0 sc1
    buffer_load_dwordx4 v[240:243], v8, s[92:95], s97 offen sc1
    s_waitcnt vmcnt(0)
C_XL:
    v_xor_b32 v18, s99, v229
    v_xor_b32 v19, s99, v231
    v_or_b32 v18, v18, v19
    v_xor_b32 v19, s99, v233
    v_or_b32 v18, v18, v19
    v_xor_b32 v19, s99, v235
    v_or_b32 v18, v18, v19
    v_xor_b32 v19, s99, v237
    v_or_b32 v18, v18, v19
    v_xor_b32 v19, s99, v239
    v_or_b32 v18, v18, v19
    v_xor_b32 v19, s99, v241
    v_or_b32 v18, v18, v19
    v_xor_b32 v19, s99, v243
    v_or_b32 v18, v18, v19
    v_cmp_ne_u32 vcc, 0, v18
    s_nop 4
    s_cbranch_vccz C_XOK
    s_sleep 8
    buffer_load_dwordx4 v[228:231], v9, s[92:95], s98 offen offset:0 sc1
    buffer_load_dwordx4 v[232:235], v9, s[92:95], s97 offen sc1
    buffer_load_dwordx4 v[236:239], v8, s[92:95], s98 offen offset:0 sc1
    buffer_load_dwordx4 v[240:243], v8, s[92:95], s97 offen sc1
    s_waitcnt vmcnt(0)
    s_branch C_XL
C_XOK:
    ds_write_b32 v10, v228 offset:34816
    ds_write_b32 v10, v230 offset:35904
    ds_write_b32 v11, v228 offset:35088
    ds_write_b32 v11, v230 offset:36176
    ds_write_b32 v12, v228 offset:35360
    ds_write_b32 v12, v230 offset:36448
    ds_write_b32 v13, v228 offset:35632
    ds_write_b32 v13, v230 offset:36720
    ds_write_b32 v10, v232 offset:43648
    ds_write_b32 v10, v234 offset:44736
    ds_write_b32 v11, v232 offset:43920
    ds_write_b32 v11, v234 offset:45008
    ds_write_b32 v12, v232 offset:44192
    ds_write_b32 v12, v234 offset:45280
    ds_write_b32 v13, v232 offset:44464
    ds_write_b32 v13, v234 offset:45552
    ds_write_b32 v10, v236 offset:52480
    ds_write_b32 v10, v238 offset:53568
    ds_write_b32 v11, v236 offset:52752
    ds_write_b32 v11, v238 offset:53840
    ds_write_b32 v12, v236 offset:53024
    ds_write_b32 v12, v238 offset:54112
    ds_write_b32 v13, v236 offset:53296
    ds_write_b32 v13, v238 offset:54384
    ds_write_b32 v10, v240 offset:61312
    ds_write_b32 v10, v242 offset:62400
    ds_write_b32 v11, v240 offset:61584
    ds_write_b32 v11, v242 offset:62672
    ds_write_b32 v12, v240 offset:61856
    ds_write_b32 v12, v242 offset:62944
    ds_write_b32 v13, v240 offset:62128
    ds_write_b32 v13, v242 offset:63216
    v_lshl_or_b32 v18, v5, 3, v4
    v_sub_u32 v18, v2, v18
    v_add_u32 v18, 15, v18
    v_and_b32 v19, 1, v1
    v_mul_u32_u24 v19, 4480, v19
    v_lshl_add_u32 v20, v18, 4, v19
    s_xor_b32 s9, s7, 1
    s_lshl_b32 s8, s9, 10
    s_add_u32 s8, s8, s12
    v_add_u32 v20, s8, v20
    v_and_b32 v18, 3, v1
    v_bfe_u32 v19, v1, 3, 1
    v_lshl_or_b32 v22, v19, 2, v18
    v_bfe_u32 v19, v1, 4, 1
    v_lshl_or_b32 v23, v5, 1, v19
    v_mul_u32_u24 v18, 2208, v22
    v_mul_u32_u24 v19, 272, v23
    v_add_u32 v18, v18, v19
    v_lshl_add_u32 v21, v2, 4, v18
    s_mul_i32 s8, s9, 8832
    s_mul_i32 s9, s6, 1088
    s_add_u32 s8, s8, s9
    v_add_u32 v21, s8, v21
    s_waitcnt lgkmcnt(0)
    s_barrier
    s_setprio 0
    ds_read_b128 v[96:99], v20 offset:3040
    ds_read_b128 v[100:103], v21 offset:26208
    ds_read_b128 v[104:107], v21 offset:43872
    ds_read_b128 v[108:111], v20 offset:992
    ds_read_b128 v[112:115], v20 offset:3008
    ds_read_b128 v[116:119], v21 offset:26176
    ds_read_b128 v[120:123], v21 offset:43840
    ds_read_b128 v[124:127], v20 offset:960
    s_waitcnt lgkmcnt(4)
    v_mfma_f32_32x32x16_bf16 v[64:79], v[96:99], v[100:103], 0
    ds_read_b128 v[128:131], v20 offset:2976
    ds_read_b128 v[132:135], v21 offset:26144
    v_mfma_f32_32x32x16_bf16 v[80:95], v[96:99], v[104:107], 0
    ds_read_b128 v[136:139], v21 offset:43808
    v_mfma_f32_32x32x16_bf16 v[80:95], v[108:111], v[100:103], v[80:95]
    ds_read_b128 v[140:143], v20 offset:928
    s_waitcnt lgkmcnt(4)
    v_mfma_f32_32x32x16_bf16 v[64:79], v[112:115], v[116:119], v[64:79]
    ds_read_b128 v[96:99], v20 offset:2944
    ds_read_b128 v[100:103], v21 offset:26112
    v_mfma_f32_32x32x16_bf16 v[80:95], v[112:115], v[120:123], v[80:95]
    ds_read_b128 v[104:107], v21 offset:43776
    v_mfma_f32_32x32x16_bf16 v[80:95], v[124:127], v[116:119], v[80:95]
    ds_read_b128 v[108:111], v20 offset:896
    s_waitcnt lgkmcnt(4)
    v_mfma_f32_32x32x16_bf16 v[64:79], v[128:131], v[132:135], v[64:79]
    ds_read_b128 v[112:115], v20 offset:2912
    ds_read_b128 v[116:119], v21 offset:26080
    v_mfma_f32_32x32x16_bf16 v[80:95], v[128:131], v[136:139], v[80:95]
    ds_read_b128 v[120:123], v21 offset:43744
    v_mfma_f32_32x32x16_bf16 v[80:95], v[140:143], v[132:135], v[80:95]
    ds_read_b128 v[124:127], v20 offset:864
    s_waitcnt lgkmcnt(4)
    v_mfma_f32_32x32x16_bf16 v[64:79], v[96:99], v[100:103], v[64:79]
    ds_read_b128 v[128:131], v20 offset:2880
    ds_read_b128 v[132:135], v21 offset:26048
    v_mfma_f32_32x32x16_bf16 v[80:95], v[96:99], v[104:107], v[80:95]
    ds_read_b128 v[136:139], v21 offset:43712
    v_mfma_f32_32x32x16_bf16 v[80:95], v[108:111], v[100:103], v[80:95]
    ds_read_b128 v[140:143], v20 offset:832
    s_waitcnt lgkmcnt(4)
    v_mfma_f32_32x32x16_bf16 v[64:79], v[112:115], v[116:119], v[64:79]
    ds_read_b128 v[96:99], v20 offset:2848
    ds_read_b128 v[100:103], v21 offset:26016
    v_mfma_f32_32x32x16_bf16 v[80:95], v[112:115], v[120:123], v[80:95]
    ds_read_b128 v[104:107], v21 offset:43680
    v_mfma_f32_32x32x16_bf16 v[80:95], v[124:127], v[116:119], v[80:95]
    ds_read_b128 v[108:111], v20 offset:800
    s_waitcnt lgkmcnt(4)
    v_mfma_f32_32x32x16_bf16 v[64:79], v[128:131], v[132:135], v[64:79]
    ds_read_b128 v[112:115], v20 offset:2816
    ds_read_b128 v[116:119], v21 offset:25984
    v_mfma_f32_32x32x16_bf16 v[80:95], v[128:131], v[136:139], v[80:95]
    ds_read_b128 v[120:123], v21 offset:43648
    v_mfma_f32_32x32x16_bf16 v[80:95], v[140:143], v[132:135], v[80:95]
    ds_read_b128 v[124:127], v20 offset:768
    s_waitcnt lgkmcnt(4)
    v_mfma_f32_32x32x16_bf16 v[64:79], v[96:99], v[100:103], v[64:79]
    ds_read_b128 v[128:131], v20 offset:2784
    ds_read_b128 v[132:135], v21 offset:24000
    v_mfma_f32_32x32x16_bf16 v[80:95], v[96:99], v[104:107], v[80:95]
    ds_read_b128 v[136:139], v21 offset:41664
    v_mfma_f32_32x32x16_bf16 v[80:95], v[108:111], v[100:103], v[80:95]
    ds_read_b128 v[140:143], v20 offset:736
    s_waitcnt lgkmcnt(4)
    v_mfma_f32_32x32x16_bf16 v[64:79], v[112:115], v[116:119], v[64:79]
    ds_read_b128 v[96:99], v20 offset:2752
    ds_read_b128 v[100:103], v21 offset:23968
    v_mfma_f32_32x32x16_bf16 v[80:95], v[112:115], v[120:123], v[80:95]
    ds_read_b128 v[104:107], v21 offset:41632
    v_mfma_f32_32x32x16_bf16 v[80:95], v[124:127], v[116:119], v[80:95]
    ds_read_b128 v[108:111], v20 offset:704
    s_waitcnt lgkmcnt(4)
    v_mfma_f32_32x32x16_bf16 v[64:79], v[128:131], v[132:135], v[64:79]
    ds_read_b128 v[112:115], v20 offset:2720
    ds_read_b128 v[116:119], v21 offset:23936
    v_mfma_f32_32x32x16_bf16 v[80:95], v[128:131], v[136:139], v[80:95]
    ds_read_b128 v[120:123], v21 offset:41600
    v_mfma_f32_32x32x16_bf16 v[80:95], v[140:143], v[132:135], v[80:95]
    ds_read_b128 v[124:127], v20 offset:672
    s_waitcnt lgkmcnt(4)
    v_mfma_f32_32x32x16_bf16 v[64:79], v[96:99], v[100:103], v[64:79]
    ds_read_b128 v[128:131], v20 offset:2688
    ds_read_b128 v[132:135], v21 offset:23904
    v_mfma_f32_32x32x16_bf16 v[80:95], v[96:99], v[104:107], v[80:95]
    ds_read_b128 v[136:139], v21 offset:41568
    v_mfma_f32_32x32x16_bf16 v[80:95], v[108:111], v[100:103], v[80:95]
    ds_read_b128 v[140:143], v20 offset:640
    s_waitcnt lgkmcnt(4)
    v_mfma_f32_32x32x16_bf16 v[64:79], v[112:115], v[116:119], v[64:79]
    ds_read_b128 v[96:99], v20 offset:2656
    ds_read_b128 v[100:103], v21 offset:23872
    v_mfma_f32_32x32x16_bf16 v[80:95], v[112:115], v[120:123], v[80:95]
    ds_read_b128 v[104:107], v21 offset:41536
    v_mfma_f32_32x32x16_bf16 v[80:95], v[124:127], v[116:119], v[80:95]
    ds_read_b128 v[108:111], v20 offset:608
    s_waitcnt lgkmcnt(4)
    v_mfma_f32_32x32x16_bf16 v[64:79], v[128:131], v[132:135], v[64:79]
    ds_read_b128 v[112:115], v20 offset:2624
    ds_read_b128 v[116:119], v21 offset:23840
    v_mfma_f32_32x32x16_bf16 v[80:95], v[128:131], v[136:139], v[80:95]
    ds_read_b128 v[120:123], v21 offset:41504
    v_mfma_f32_32x32x16_bf16 v[80:95], v[140:143], v[132:135], v[80:95]
    ds_read_b128 v[124:127], v20 offset:576
    s_waitcnt lgkmcnt(4)
    v_mfma_f32_32x32x16_bf16 v[64:79], v[96:99], v[100:103], v[64:79]
    ds_read_b128 v[128:131], v20 offset:2592
    ds_read_b128 v[132:135], v21 offset:23808
    v_mfma_f32_32x32x16_bf16 v[80:95], v[96:99], v[104:107], v[80:95]
    ds_read_b128 v[136:139], v21 offset:41472
    v_mfma_f32_32x32x16_bf16 v[80:95], v[108:111], v[100:103], v[80:95]
    ds_read_b128 v[140:143], v20 offset:544
    s_waitcnt lgkmcnt(4)
    v_mfma_f32_32x32x16_bf16 v[64:79], v[112:115], v[116:119], v[64:79]
    ds_read_b128 v[96:99], v20 offset:2560
    ds_read_b128 v[100:103], v21 offset:23776
    v_mfma_f32_32x32x16_bf16 v[80:95], v[112:115], v[120:123], v[80:95]
    ds_read_b128 v[104:107], v21 offset:41440
    v_mfma_f32_32x32x16_bf16 v[80:95], v[124:127], v[116:119], v[80:95]
    ds_read_b128 v[108:111], v20 offset:512
    s_waitcnt lgkmcnt(4)
    v_mfma_f32_32x32x16_bf16 v[64:79], v[128:131], v[132:135], v[64:79]
    ds_read_b128 v[112:115], v20 offset:2528
    ds_read_b128 v[116:119], v21 offset:21792
    v_mfma_f32_32x32x16_bf16 v[80:95], v[128:131], v[136:139], v[80:95]
    ds_read_b128 v[120:123], v21 offset:39456
    v_mfma_f32_32x32x16_bf16 v[80:95], v[140:143], v[132:135], v[80:95]
    ds_read_b128 v[124:127], v20 offset:480
    s_waitcnt lgkmcnt(4)
    v_mfma_f32_32x32x16_bf16 v[64:79], v[96:99], v[100:103], v[64:79]
    ds_read_b128 v[128:131], v20 offset:2496
    ds_read_b128 v[132:135], v21 offset:21760
    v_mfma_f32_32x32x16_bf16 v[80:95], v[96:99], v[104:107], v[80:95]
    ds_read_b128 v[136:139], v21 offset:39424
    v_mfma_f32_32x32x16_bf16 v[80:95], v[108:111], v[100:103], v[80:95]
    ds_read_b128 v[140:143], v20 offset:448
    s_waitcnt lgkmcnt(4)
    v_mfma_f32_32x32x16_bf16 v[64:79], v[112:115], v[116:119], v[64:79]
    ds_read_b128 v[96:99], v20 offset:2464
    ds_read_b128 v[100:103], v21 offset:21728
    v_mfma_f32_32x32x16_bf16 v[80:95], v[112:115], v[120:123], v[80:95]
    ds_read_b128 v[104:107], v21 offset:39392
    v_mfma_f32_32x32x16_bf16 v[80:95], v[124:127], v[116:119], v[80:95]
    ds_read_b128 v[108:111], v20 offset:416
    s_waitcnt lgkmcnt(4)
    v_mfma_f32_32x32x16_bf16 v[64:79], v[128:131], v[132:135], v[64:79]
    ds_read_b128 v[112:115], v20 offset:2432
    ds_read_b128 v[116:119], v21 offset:21696
    v_mfma_f32_32x32x16_bf16 v[80:95], v[128:131], v[136:139], v[80:95]
    ds_read_b128 v[120:123], v21 offset:39360
    v_mfma_f32_32x32x16_bf16 v[80:95], v[140:143], v[132:135], v[80:95]
    ds_read_b128 v[124:127], v20 offset:384
    s_waitcnt lgkmcnt(4)
    v_mfma_f32_32x32x16_bf16 v[64:79], v[96:99], v[100:103], v[64:79]
    ds_read_b128 v[128:131], v20 offset:2400
    ds_read_b128 v[132:135], v21 offset:21664
    v_mfma_f32_32x32x16_bf16 v[80:95], v[96:99], v[104:107], v[80:95]
    ds_read_b128 v[136:139], v21 offset:39328
    v_mfma_f32_32x32x16_bf16 v[80:95], v[108:111], v[100:103], v[80:95]
    ds_read_b128 v[140:143], v20 offset:352
    s_waitcnt lgkmcnt(4)
    v_mfma_f32_32x32x16_bf16 v[64:79], v[112:115], v[116:119], v[64:79]
    ds_read_b128 v[96:99], v20 offset:2368
    ds_read_b128 v[100:103], v21 offset:21632
    v_mfma_f32_32x32x16_bf16 v[80:95], v[112:115], v[120:123], v[80:95]
    ds_read_b128 v[104:107], v21 offset:39296
    v_mfma_f32_32x32x16_bf16 v[80:95], v[124:127], v[116:119], v[80:95]
    ds_read_b128 v[108:111], v20 offset:320
    s_waitcnt lgkmcnt(4)
    v_mfma_f32_32x32x16_bf16 v[64:79], v[128:131], v[132:135], v[64:79]
    ds_read_b128 v[112:115], v20 offset:2336
    ds_read_b128 v[116:119], v21 offset:21600
    v_mfma_f32_32x32x16_bf16 v[80:95], v[128:131], v[136:139], v[80:95]
    ds_read_b128 v[120:123], v21 offset:39264
    v_mfma_f32_32x32x16_bf16 v[80:95], v[140:143], v[132:135], v[80:95]
    ds_read_b128 v[124:127], v20 offset:288
    s_waitcnt lgkmcnt(4)
    v_mfma_f32_32x32x16_bf16 v[64:79], v[96:99], v[100:103], v[64:79]
    ds_read_b128 v[128:131], v20 offset:2304
    ds_read_b128 v[132:135], v21 offset:21568
    v_mfma_f32_32x32x16_bf16 v[80:95], v[96:99], v[104:107], v[80:95]
    ds_read_b128 v[136:139], v21 offset:39232
    v_mfma_f32_32x32x16_bf16 v[80:95], v[108:111], v[100:103], v[80:95]
    ds_read_b128 v[140:143], v20 offset:256
    s_waitcnt lgkmcnt(4)
    v_mfma_f32_32x32x16_bf16 v[64:79], v[112:115], v[116:119], v[64:79]
    ds_read_b128 v[96:99], v20 offset:2272
    ds_read_b128 v[100:103], v21 offset:19584
    v_mfma_f32_32x32x16_bf16 v[80:95], v[112:115], v[120:123], v[80:95]
    ds_read_b128 v[104:107], v21 offset:37248
    v_mfma_f32_32x32x16_bf16 v[80:95], v[124:127], v[116:119], v[80:95]
    ds_read_b128 v[108:111], v20 offset:224
    s_waitcnt lgkmcnt(4)
    v_mfma_f32_32x32x16_bf16 v[64:79], v[128:131], v[132:135], v[64:79]
    ds_read_b128 v[112:115], v20 offset:2240
    ds_read_b128 v[116:119], v21 offset:19552
    v_mfma_f32_32x32x16_bf16 v[80:95], v[128:131], v[136:139], v[80:95]
    ds_read_b128 v[120:123], v21 offset:37216
    v_mfma_f32_32x32x16_bf16 v[80:95], v[140:143], v[132:135], v[80:95]
    ds_read_b128 v[124:127], v20 offset:192
    s_waitcnt lgkmcnt(4)
    v_mfma_f32_32x32x16_bf16 v[64:79], v[96:99], v[100:103], v[64:79]
    ds_read_b128 v[128:131], v20 offset:2208
    ds_read_b128 v[132:135], v21 offset:19520
    v_mfma_f32_32x32x16_bf16 v[80:95], v[96:99], v[104:107], v[80:95]
    ds_read_b128 v[136:139], v21 offset:37184
    v_mfma_f32_32x32x16_bf16 v[80:95], v[108:111], v[100:103], v[80:95]
    ds_read_b128 v[140:143], v20 offset:160
    s_waitcnt lgkmcnt(4)
    v_mfma_f32_32x32x16_bf16 v[64:79], v[112:115], v[116:119], v[64:79]
    ds_read_b128 v[96:99], v20 offset:2176
    ds_read_b128 v[100:103], v21 offset:19488
    v_mfma_f32_32x32x16_bf16 v[80:95], v[112:115], v[120:123], v[80:95]
    ds_read_b128 v[104:107], v21 offset:37152
    v_mfma_f32_32x32x16_bf16 v[80:95], v[124:127], v[116:119], v[80:95]
    ds_read_b128 v[108:111], v20 offset:128
    s_waitcnt lgkmcnt(4)
    v_mfma_f32_32x32x16_bf16 v[64:79], v[128:131], v[132:135], v[64:79]
    ds_read_b128 v[112:115], v20 offset:2144
    ds_read_b128 v[116:119], v21 offset:19456
    v_mfma_f32_32x32x16_bf16 v[80:95], v[128:131], v[136:139], v[80:95]
    ds_read_b128 v[120:123], v21 offset:37120
    v_mfma_f32_32x32x16_bf16 v[80:95], v[140:143], v[132:135], v[80:95]
    ds_read_b128 v[124:127], v20 offset:96
    s_waitcnt lgkmcnt(4)
    v_mfma_f32_32x32x16_bf16 v[64:79], v[96:99], v[100:103], v[64:79]
    ds_read_b128 v[128:131], v20 offset:2112
    ds_read_b128 v[132:135], v21 offset:19424
    v_mfma_f32_32x32x16_bf16 v[80:95], v[96:99], v[104:107], v[80:95]
    ds_read_b128 v[136:139], v21 offset:37088
    v_mfma_f32_32x32x16_bf16 v[80:95], v[108:111], v[100:103], v[80:95]
    ds_read_b128 v[140:143], v20 offset:64
    s_waitcnt lgkmcnt(4)
    v_mfma_f32_32x32x16_bf16 v[64:79], v[112:115], v[116:119], v[64:79]
    ds_read_b128 v[96:99], v20 offset:2080
    ds_read_b128 v[100:103], v21 offset:19392
    v_mfma_f32_32x32x16_bf16 v[80:95], v[112:115], v[120:123], v[80:95]
    ds_read_b128 v[104:107], v21 offset:37056
    v_mfma_f32_32x32x16_bf16 v[80:95], v[124:127], v[116:119], v[80:95]
    ds_read_b128 v[108:111], v20 offset:32
    s_waitcnt lgkmcnt(4)
    v_mfma_f32_32x32x16_bf16 v[64:79], v[128:131], v[132:135], v[64:79]
    ds_read_b128 v[112:115], v20 offset:2048
    ds_read_b128 v[116:119], v21 offset:19360
    v_mfma_f32_32x32x16_bf16 v[80:95], v[128:131], v[136:139], v[80:95]
    ds_read_b128 v[120:123], v21 offset:37024
    v_mfma_f32_32x32x16_bf16 v[80:95], v[140:143], v[132:135], v[80:95]
    ds_read_b128 v[124:127], v20 offset:0
    s_waitcnt lgkmcnt(4)
    v_mfma_f32_32x32x16_bf16 v[64:79], v[96:99], v[100:103], v[64:79]
    v_mfma_f32_32x32x16_bf16 v[80:95], v[96:99], v[104:107], v[80:95]
    v_mfma_f32_32x32x16_bf16 v[80:95], v[108:111], v[100:103], v[80:95]
    s_waitcnt lgkmcnt(0)
    v_mfma_f32_32x32x16_bf16 v[64:79], v[112:115], v[116:119], v[64:79]
    v_mfma_f32_32x32x16_bf16 v[80:95], v[112:115], v[120:123], v[80:95]
    v_mfma_f32_32x32x16_bf16 v[80:95], v[124:127], v[116:119], v[80:95]
    s_barrier
    s_lshl_b32 s8, s3, 12
    v_lshl_add_u32 v16, v1, 4, s8
    v_xor_b32 v17, 4096, v16
    s_lshl_b32 s8, s5, 12
    s_lshl_b32 s9, s7, 11
    s_add_u32 s8, s8, s9
    s_add_u32 s8, s8, 5242880
    v_lshl_or_b32 v18, v22, 2, v23
    v_lshl_or_b32 v18, v18, 1, v2
    v_lshlrev_b32 v18, 4, v18
    s_nop 3
    s_cmp_eq_u32 s7, 0
    s_cbranch_scc1 C_F0
    ds_write_b128 v16, v[64:67] offset:0
    ds_write_b128 v16, v[68:71] offset:1024
    ds_write_b128 v16, v[72:75] offset:2048
    ds_write_b128 v16, v[76:79] offset:3072
    s_waitcnt lgkmcnt(0)
    s_barrier
    ds_read_b128 v[96:99], v17 offset:0
    ds_read_b128 v[100:103], v17 offset:1024
    ds_read_b128 v[104:107], v17 offset:2048
    ds_read_b128 v[108:111], v17 offset:3072
    s_waitcnt lgkmcnt(0)
    v_add_f32 v96, v96, v80
    v_add_f32 v97, v97, v81
    v_cvt_pk_bf16_f32 v112, v96, v97
    v_add_f32 v98, v98, v82
    v_add_f32 v99, v99, v83
    v_cvt_pk_bf16_f32 v113, v98, v99
    v_add_f32 v100, v100, v84
    v_add_f32 v101, v101, v85
    v_cvt_pk_bf16_f32 v114, v100, v101
    v_add_f32 v102, v102, v86
    v_add_f32 v103, v103, v87
    v_cvt_pk_bf16_f32 v115, v102, v103
    v_add_f32 v104, v104, v88
    v_add_f32 v105, v105, v89
    v_cvt_pk_bf16_f32 v116, v104, v105
    v_add_f32 v106, v106, v90
    v_add_f32 v107, v107, v91
    v_cvt_pk_bf16_f32 v117, v106, v107
    v_add_f32 v108, v108, v92
    v_add_f32 v109, v109, v93
    v_cvt_pk_bf16_f32 v118, v108, v109
    v_add_f32 v110, v110, v94
    v_add_f32 v111, v111, v95
    v_cvt_pk_bf16_f32 v119, v110, v111
    buffer_store_dwordx4 v[112:115], v18, s[92:95], s8 offen sc1
    buffer_store_dwordx4 v[116:119], v18, s[92:95], s8 offen offset:1024 sc1
    s_branch C_FD
C_F0:
    ds_write_b128 v16, v[80:83] offset:0
    ds_write_b128 v16, v[84:87] offset:1024
    ds_write_b128 v16, v[88:91] offset:2048
    ds_write_b128 v16, v[92:95] offset:3072
    s_waitcnt lgkmcnt(0)
    s_barrier
    ds_read_b128 v[96:99], v17 offset:0
    ds_read_b128 v[100:103], v17 offset:1024
    ds_read_b128 v[104:107], v17 offset:2048
    ds_read_b128 v[108:111], v17 offset:3072
    s_waitcnt lgkmcnt(0)
    v_add_f32 v96, v96, v64
    v_add_f32 v97, v97, v65
    v_cvt_pk_bf16_f32 v112, v96, v97
    v_add_f32 v98, v98, v66
    v_add_f32 v99, v99, v67
    v_cvt_pk_bf16_f32 v113, v98, v99
    v_add_f32 v100, v100, v68
    v_add_f32 v101, v101, v69
    v_cvt_pk_bf16_f32 v114, v100, v101
    v_add_f32 v102, v102, v70
    v_add_f32 v103, v103, v71
    v_cvt_pk_bf16_f32 v115, v102, v103
    v_add_f32 v104, v104, v72
    v_add_f32 v105, v105, v73
    v_cvt_pk_bf16_f32 v116, v104, v105
    v_add_f32 v106, v106, v74
    v_add_f32 v107, v107, v75
    v_cvt_pk_bf16_f32 v117, v106, v107
    v_add_f32 v108, v108, v76
    v_add_f32 v109, v109, v77
    v_cvt_pk_bf16_f32 v118, v108, v109
    v_add_f32 v110, v110, v78
    v_add_f32 v111, v111, v79
    v_cvt_pk_bf16_f32 v119, v110, v111
    buffer_store_dwordx4 v[112:115], v18, s[92:95], s8 offen sc1
    buffer_store_dwordx4 v[116:119], v18, s[92:95], s8 offen offset:1024 sc1
C_FD:
    v_lshlrev_b32 v84, 16, v212
    v_and_b32 v85, 0xffff0000, v212
    v_lshlrev_b32 v86, 16, v220
    v_and_b32 v87, 0xffff0000, v220
    v_mul_f32 v84, v84, v86
    v_mul_f32 v85, v85, v87
    v_cvt_pk_bf16_f32 v84, v84, v85
    v_and_b32 v85, 0xffff0000, v84
    v_lshlrev_b32 v84, 16, v84
    v_add_f32 v88, v84, v85
    v_lshlrev_b32 v84, 16, v213
    v_and_b32 v85, 0xffff0000, v213
    v_lshlrev_b32 v86, 16, v221
    v_and_b32 v87, 0xffff0000, v221
    v_mul_f32 v84, v84, v86
    v_mul_f32 v85, v85, v87
    v_cvt_pk_bf16_f32 v84, v84, v85
    v_and_b32 v85, 0xffff0000, v84
    v_lshlrev_b32 v84, 16, v84
    v_add_f32 v88, v88, v84
    v_add_f32 v88, v88, v85
    v_lshlrev_b32 v84, 16, v214
    v_and_b32 v85, 0xffff0000, v214
    v_lshlrev_b32 v86, 16, v222
    v_and_b32 v87, 0xffff0000, v222
    v_mul_f32 v84, v84, v86
    v_mul_f32 v85, v85, v87
    v_cvt_pk_bf16_f32 v84, v84, v85
    v_and_b32 v85, 0xffff0000, v84
    v_lshlrev_b32 v84, 16, v84
    v_add_f32 v88, v88, v84
    v_add_f32 v88, v88, v85
    v_lshlrev_b32 v84, 16, v215
    v_and_b32 v85, 0xffff0000, v215
    v_lshlrev_b32 v86, 16, v223
    v_and_b32 v87, 0xffff0000, v223
    v_mul_f32 v84, v84, v86
    v_mul_f32 v85, v85, v87
    v_cvt_pk_bf16_f32 v84, v84, v85
    v_and_b32 v85, 0xffff0000, v84
    v_lshlrev_b32 v84, 16, v84
    v_add_f32 v88, v88, v84
    v_add_f32 v88, v88, v85
    v_lshlrev_b32 v84, 16, v216
    v_and_b32 v85, 0xffff0000, v216
    v_lshlrev_b32 v86, 16, v220
    v_and_b32 v87, 0xffff0000, v220
    v_mul_f32 v84, v84, v86
    v_mul_f32 v85, v85, v87
    v_cvt_pk_bf16_f32 v84, v84, v85
    v_and_b32 v85, 0xffff0000, v84
    v_lshlrev_b32 v84, 16, v84
    v_add_f32 v89, v84, v85
    v_lshlrev_b32 v84, 16, v217
    v_and_b32 v85, 0xffff0000, v217
    v_lshlrev_b32 v86, 16, v221
    v_and_b32 v87, 0xffff0000, v221
    v_mul_f32 v84, v84, v86
    v_mul_f32 v85, v85, v87
    v_cvt_pk_bf16_f32 v84, v84, v85
    v_and_b32 v85, 0xffff0000, v84
    v_lshlrev_b32 v84, 16, v84
    v_add_f32 v89, v89, v84
    v_add_f32 v89, v89, v85
    v_lshlrev_b32 v84, 16, v218
    v_and_b32 v85, 0xffff0000, v218
    v_lshlrev_b32 v86, 16, v222
    v_and_b32 v87, 0xffff0000, v222
    v_mul_f32 v84, v84, v86
    v_mul_f32 v85, v85, v87
    v_cvt_pk_bf16_f32 v84, v84, v85
    v_and_b32 v85, 0xffff0000, v84
    v_lshlrev_b32 v84, 16, v84
    v_add_f32 v89, v89, v84
    v_add_f32 v89, v89, v85
    v_lshlrev_b32 v84, 16, v219
    v_and_b32 v85, 0xffff0000, v219
    v_lshlrev_b32 v86, 16, v223
    v_and_b32 v87, 0xffff0000, v223
    v_mul_f32 v84, v84, v86
    v_mul_f32 v85, v85, v87
    v_cvt_pk_bf16_f32 v84, v84, v85
    v_and_b32 v85, 0xffff0000, v84
    v_lshlrev_b32 v84, 16, v84
    v_add_f32 v89, v89, v84
    v_add_f32 v89, v89, v85
    s_nop 0
    v_add_f32_dpp v88, v88, v88 row_shr:1
    v_add_f32_dpp v89, v89, v89 row_shr:1
    s_nop 0
    v_add_f32_dpp v88, v88, v88 row_shr:2
    v_add_f32_dpp v89, v89, v89 row_shr:2
    s_nop 0
    v_add_f32_dpp v88, v88, v88 row_shr:4
    v_add_f32_dpp v89, v89, v89 row_shr:4
    s_nop 0
    v_add_f32_dpp v88, v88, v88 row_shr:8
    v_add_f32_dpp v89, v89, v89 row_shr:8
    s_nop 0
    v_add_f32_dpp v88, v88, v88 row_bcast:15 row_mask:0xa
    v_add_f32_dpp v89, v89, v89 row_bcast:15 row_mask:0xa
    s_nop 0
    v_add_f32_dpp v88, v88, v88 row_bcast:31 row_mask:0xc
    v_add_f32_dpp v89, v89, v89 row_bcast:31 row_mask:0xc
    v_cvt_pk_bf16_f32 v88, v88, v88
    v_and_b32 v88, 0xffff0000, v88
    v_mul_f32 v88, 0xbfb8aa3b, v88
    v_exp_f32 v88, v88
    s_nop 0
    v_add_f32 v88, 1.0, v88
    v_rcp_f32 v88, v88
    s_nop 0
    v_cvt_pk_bf16_f32 v89, v89, v89
    v_and_b32 v89, 0xffff0000, v89
    v_mul_f32 v89, 0xbfb8aa3b, v89
    v_exp_f32 v89, v89
    s_nop 0
    v_add_f32 v89, 1.0, v89
    v_rcp_f32 v89, v89
    s_nop 0
    v_cvt_pk_bf16_f32 v88, v88, v89
    v_mov_b32 v89, s99
    s_lshr_b32 s8, s4, 3
    s_lshr_b32 s9, s4, 1
    s_xor_b32 s8, s8, s9
    s_lshr_b32 s9, s4, 2
    s_xor_b32 s8, s8, s9
    s_and_b32 s8, s8, 1
    s_lshl_b32 s8, s8, 6
    s_and_b32 s9, s4, 7
    s_lshl_b32 s9, s9, 3
    s_add_u32 s8, s8, s9
    s_lshr_b32 s9, s4, 4
    s_lshl_b32 s9, s9, 9
    s_add_u32 s8, s8, s9
    s_sub_u32 s9, 3, s3
    s_lshl_b32 s9, s9, 7
    s_add_u32 s8, s8, s9
    s_add_u32 s8, s8, 7340032
    v_cmp_eq_u32 vcc, 63, v1
    v_mov_b32 v18, 0x7ffffff0
    s_nop 0
    v_cndmask_b32 v18, v18, v224, vcc
    buffer_store_dwordx2 v[88:89], v18, s[92:95], s8 offen sc1
    s_lshl_b32 s8, s5, 7
    s_lshl_b32 s9, s7, 16
    s_add_u32 s8, s8, s9
    s_add_u32 s8, s8, 7733248
    s_waitcnt vmcnt(1)
    v_mov_b32 v18, s99
    v_lshlrev_b32 v19, 24, v1
    buffer_store_dword v18, v19, s[92:95], s8 offen sc1
    s_endpgm
K1_GEMM:
    s_and_b32 s6, s2, 7
    s_bfe_u32 s7, s2, 0x50003
    s_lshr_b32 s4, s6, 1
    s_lshl_b32 s4, s4, 2
    s_and_b32 s8, s7, 3
    s_add_u32 s4, s4, s8
    s_and_b32 s5, s6, 1
    s_lshl_b32 s5, s5, 3
    s_lshr_b32 s8, s7, 2
    s_add_u32 s5, s5, s8
    s_bfe_u32 s88, s7, 0x10002
    s_and_b32 s89, s6, 1
    s_lshl_b32 s89, s89, 2
    s_lshr_b32 s9, s7, 3
    s_add_u32 s89, s89, s9
    s_and_b32 s90, s7, 3
    s_lshl_b32 s90, s90, 1
    s_add_u32 s90, s90, s8
    s_lshl_b32 s90, s90, 7
    v_lshrrev_b32 v6, 3, v1
    v_and_b32 v7, 7, v1
    v_bfe_u32 v8, v6, 1, 1
    v_xor_b32 v7, v7, v8
    v_and_b32 v9, 1, v6
    v_lshl_or_b32 v9, v9, 3, v8
    v_lshrrev_b32 v10, 2, v6
    v_lshl_or_b32 v9, v10, 4, v9
    s_lshl_b32 s8, s3, 5
    v_add_u32 v9, s8, v9
    v_xor_b32 v10, 0, v7
    v_lshlrev_b32 v10, 4, v10
    v_add_u32 v11, 0, v9
    v_lshl_add_u32 v12, v11, 10, v10
    v_xor_b32 v10, 2, v7
    v_lshlrev_b32 v10, 4, v10
    v_add_u32 v11, 2, v9
    v_lshl_add_u32 v13, v11, 10, v10
    v_xor_b32 v10, 4, v7
    v_lshlrev_b32 v10, 4, v10
    v_add_u32 v11, 4, v9
    v_lshl_add_u32 v14, v11, 10, v10
    v_xor_b32 v10, 6, v7
    v_lshlrev_b32 v10, 4, v10
    v_add_u32 v11, 6, v9
    v_lshl_add_u32 v15, v11, 10, v10
    s_and_b32 s8, s3, 1
    s_lshl_b32 s9, s8, 2
    s_lshl_b32 s8, s8, 4
    v_xor_b32 v10, s9, v7
    v_xor_b32 v10, 0, v10
    v_lshlrev_b32 v10, 4, v10
    v_add3_u32 v11, s8, v6, 0
    v_lshl_add_u32 v16, v11, 10, v10
    v_xor_b32 v10, s9, v7
    v_xor_b32 v10, 2, v10
    v_lshlrev_b32 v10, 4, v10
    v_add3_u32 v11, s8, v6, 8
    v_lshl_add_u32 v17, v11, 10, v10
    s_waitcnt lgkmcnt(0)
    s_lshl_b32 s8, s4, 17
    s_add_u32 s56, s16, s8
    s_addc_u32 s57, s17, 0
    s_mov_b32 s58, 131072
    s_mov_b32 s59, 0x20000
    s_cmp_lt_u32 s3, 2
    s_cselect_b32 s10, s36, s38
    s_cselect_b32 s11, s37, s39
    s_lshl_b32 s8, s5, 15
    s_add_u32 s60, s10, s8
    s_addc_u32 s61, s11, 0
    s_mov_b32 s62, 32768
    s_mov_b32 s63, 0x20000
    s_mov_b32 s64, s32
    s_mov_b32 s65, s33
    s_mov_b32 s66, 1024
    s_mov_b32 s67, 0x20000
    s_mov_b32 s68, s34
    s_mov_b32 s69, s35
    s_mov_b32 s70, 1024
    s_mov_b32 s71, 0x20000
    s_mov_b32 s72, s44
    s_mov_b32 s73, s45
    s_mov_b32 s74, 1024
    s_mov_b32 s75, 0x20000
    s_lshl_b32 s8, s5, 13
    s_add_u32 s8, s8, 7405568
    s_add_u32 s76, s54, s8
    s_addc_u32 s77, s55, 0
    s_mov_b32 s78, 8192
    s_mov_b32 s79, 0x20000
    s_mov_b32 s80, s52
    s_mov_b32 s81, s53
    s_mov_b32 s82, 256
    s_mov_b32 s83, 0x20000
    s_lshl_b32 s8, s4, 18
    s_add_u32 s84, s54, s8
    s_addc_u32 s85, s55, 0
    s_mov_b32 s86, 262144
    s_mov_b32 s87, 0x20000
    s_lshl_b32 s8, s5, 6
    v_lshl_add_u32 v10, v3, 1, s8
    buffer_load_ushort v20, v10, s[64:67], 0 offen
    buffer_load_ushort v21, v10, s[68:71], 0 offen
    buffer_load_ushort v22, v10, s[72:75], 0 offen
    s_lshl_b32 s8, s4, 9
    v_lshl_add_u32 v18, v3, 4, s8
    v_mov_b32 v10, 0x7ffffff0
    v_cmp_lt_u32 vcc, 223, v0
    v_mov_b32 v24, 0
    v_mov_b32 v25, 0
    v_cndmask_b32 v18, v10, v18, vcc
    v_mov_b32 v26, 0
    v_mov_b32 v27, 0
    s_mov_b32 s92, s54
    s_mov_b32 s93, s55
    s_mov_b32 s94, 16777216
    s_mov_b32 s95, 0x20000
    s_lshl_b32 s13, s3, 12
    s_lshl_b32 s14, s3, 11
    s_add_u32 s14, s14, 16384
    s_add_u32 s15, s90, 0
    s_and_b32 s15, s15, 1023
    s_add_u32 m0, s13, 0
    s_nop 0
    buffer_load_dwordx4 v12, s[56:59], s15 offen lds
    s_add_u32 m0, s13, 1024
    s_nop 0
    buffer_load_dwordx4 v13, s[56:59], s15 offen lds
    s_add_u32 m0, s13, 2048
    s_nop 0
    buffer_load_dwordx4 v14, s[56:59], s15 offen lds
    s_add_u32 m0, s13, 3072
    s_nop 0
    buffer_load_dwordx4 v15, s[56:59], s15 offen lds
    s_add_u32 m0, s14, 0
    s_nop 0
    buffer_load_dwordx4 v16, s[60:63], s15 offen lds
    s_add_u32 m0, s14, 1024
    s_nop 0
    buffer_load_dwordx4 v17, s[60:63], s15 offen lds
    s_add_u32 s15, s90, 128
    s_and_b32 s15, s15, 1023
    s_add_u32 m0, s13, 24576
    s_nop 0
    buffer_load_dwordx4 v12, s[56:59], s15 offen lds
    s_add_u32 m0, s13, 25600
    s_nop 0
    buffer_load_dwordx4 v13, s[56:59], s15 offen lds
    s_add_u32 m0, s13, 26624
    s_nop 0
    buffer_load_dwordx4 v14, s[56:59], s15 offen lds
    s_add_u32 m0, s13, 27648
    s_nop 0
    buffer_load_dwordx4 v15, s[56:59], s15 offen lds
    s_add_u32 m0, s14, 24576
    s_nop 0
    buffer_load_dwordx4 v16, s[60:63], s15 offen lds
    s_add_u32 m0, s14, 25600
    s_nop 0
    buffer_load_dwordx4 v17, s[60:63], s15 offen lds
    s_setprio 3
    v_or_b32 v10, 0, v2
    v_xor_b32 v10, v10, v4
    v_lshlrev_b32 v10, 4, v10
    v_lshl_add_u32 v28, v3, 7, v10
    v_add_u32 v32, s13, v28
    v_add_u32 v28, 16384, v28
    v_or_b32 v10, 2, v2
    v_xor_b32 v10, v10, v4
    v_lshlrev_b32 v10, 4, v10
    v_lshl_add_u32 v29, v3, 7, v10
    v_add_u32 v33, s13, v29
    v_add_u32 v29, 16384, v29
    v_or_b32 v10, 4, v2
    v_xor_b32 v10, v10, v4
    v_lshlrev_b32 v10, 4, v10
    v_lshl_add_u32 v30, v3, 7, v10
    v_add_u32 v34, s13, v30
    v_add_u32 v30, 16384, v30
    v_or_b32 v10, 6, v2
    v_xor_b32 v10, v10, v4
    v_lshlrev_b32 v10, 4, v10
    v_lshl_add_u32 v31, v3, 7, v10
    v_add_u32 v35, s13, v31
    v_add_u32 v31, 16384, v31
    s_waitcnt vmcnt(6)
    s_barrier
    ds_read_b128 v[96:99], v32 offset:0
    ds_read_b128 v[100:103], v28 offset:0
    ds_read_b128 v[104:107], v28 offset:4096
    ds_read_b128 v[108:111], v33 offset:0
    ds_read_b128 v[112:115], v29 offset:0
    ds_read_b128 v[116:119], v29 offset:4096
    ds_read_b128 v[120:123], v34 offset:0
    ds_read_b128 v[124:127], v30 offset:0
    ds_read_b128 v[128:131], v30 offset:4096
    ds_read_b128 v[132:135], v35 offset:0
    ds_read_b128 v[136:139], v31 offset:0
    ds_read_b128 v[140:143], v31 offset:4096
    s_add_u32 s15, s90, 256
    s_and_b32 s15, s15, 1023
    s_add_u32 m0, s13, 49152
    s_nop 0
    buffer_load_dwordx4 v12, s[56:59], s15 offen lds
    s_add_u32 m0, s13, 50176
    s_nop 0
    buffer_load_dwordx4 v13, s[56:59], s15 offen lds
    s_add_u32 m0, s13, 51200
    s_nop 0
    buffer_load_dwordx4 v14, s[56:59], s15 offen lds
    s_add_u32 m0, s13, 52224
    s_nop 0
    buffer_load_dwordx4 v15, s[56:59], s15 offen lds
    s_add_u32 m0, s14, 49152
    s_nop 0
    buffer_load_dwordx4 v16, s[60:63], s15 offen lds
    s_add_u32 m0, s14, 50176
    s_nop 0
    buffer_load_dwordx4 v17, s[60:63], s15 offen lds
    s_waitcnt vmcnt(6) lgkmcnt(0)
    s_barrier
    v_mfma_f32_32x32x16_bf16 v[64:79], v[96:99], v[100:103], 0
    s_add_u32 s15, s90, 384
    s_and_b32 s15, s15, 1023
    s_add_u32 m0, s13, 0
    s_nop 0
    buffer_load_dwordx4 v12, s[56:59], s15 offen lds
    v_mfma_f32_32x32x16_bf16 v[80:95], v[96:99], v[104:107], 0
    s_add_u32 m0, s13, 1024
    s_nop 0
    buffer_load_dwordx4 v13, s[56:59], s15 offen lds
    ds_read_b128 v[144:147], v32 offset:24576
    ds_read_b128 v[148:151], v28 offset:24576
    ds_read_b128 v[152:155], v28 offset:28672
    v_mfma_f32_32x32x16_bf16 v[64:79], v[108:111], v[112:115], v[64:79]
    s_add_u32 m0, s13, 2048
    s_nop 0
    buffer_load_dwordx4 v14, s[56:59], s15 offen lds
    ds_read_b128 v[156:159], v33 offset:24576
    ds_read_b128 v[160:163], v29 offset:24576
    ds_read_b128 v[164:167], v29 offset:28672
    v_mfma_f32_32x32x16_bf16 v[80:95], v[108:111], v[116:119], v[80:95]
    s_add_u32 m0, s13, 3072
    s_nop 0
    buffer_load_dwordx4 v15, s[56:59], s15 offen lds
    ds_read_b128 v[168:171], v34 offset:24576
    ds_read_b128 v[172:175], v30 offset:24576
    ds_read_b128 v[176:179], v30 offset:28672
    v_mfma_f32_32x32x16_bf16 v[64:79], v[120:123], v[124:127], v[64:79]
    s_add_u32 m0, s14, 0
    s_nop 0
    buffer_load_dwordx4 v16, s[60:63], s15 offen lds
    ds_read_b128 v[180:183], v35 offset:24576
    ds_read_b128 v[184:187], v31 offset:24576
    ds_read_b128 v[188:191], v31 offset:28672
    v_mfma_f32_32x32x16_bf16 v[80:95], v[120:123], v[128:131], v[80:95]
    s_add_u32 m0, s14, 1024
    s_nop 0
    buffer_load_dwordx4 v17, s[60:63], s15 offen lds
    v_mfma_f32_32x32x16_bf16 v[64:79], v[132:135], v[136:139], v[64:79]
    v_mfma_f32_32x32x16_bf16 v[80:95], v[132:135], v[140:143], v[80:95]
    s_waitcnt vmcnt(6) lgkmcnt(0)
    s_barrier
    v_mfma_f32_32x32x16_bf16 v[64:79], v[144:147], v[148:151], v[64:79]
    s_add_u32 s15, s90, 512
    s_and_b32 s15, s15, 1023
    s_add_u32 m0, s13, 24576
    s_nop 0
    buffer_load_dwordx4 v12, s[56:59], s15 offen lds
    v_mfma_f32_32x32x16_bf16 v[80:95], v[144:147], v[152:155], v[80:95]
    s_add_u32 m0, s13, 25600
    s_nop 0
    buffer_load_dwordx4 v13, s[56:59], s15 offen lds
    ds_read_b128 v[96:99], v32 offset:49152
    ds_read_b128 v[100:103], v28 offset:49152
    ds_read_b128 v[104:107], v28 offset:53248
    v_mfma_f32_32x32x16_bf16 v[64:79], v[156:159], v[160:163], v[64:79]
    s_add_u32 m0, s13, 26624
    s_nop 0
    buffer_load_dwordx4 v14, s[56:59], s15 offen lds
    ds_read_b128 v[108:111], v33 offset:49152
    ds_read_b128 v[112:115], v29 offset:49152
    ds_read_b128 v[116:119], v29 offset:53248
    v_mfma_f32_32x32x16_bf16 v[80:95], v[156:159], v[164:167], v[80:95]
    s_add_u32 m0, s13, 27648
    s_nop 0
    buffer_load_dwordx4 v15, s[56:59], s15 offen lds
    ds_read_b128 v[120:123], v34 offset:49152
    ds_read_b128 v[124:127], v30 offset:49152
    ds_read_b128 v[128:131], v30 offset:53248
    v_mfma_f32_32x32x16_bf16 v[64:79], v[168:171], v[172:175], v[64:79]
    s_add_u32 m0, s14, 24576
    s_nop 0
    buffer_load_dwordx4 v16, s[60:63], s15 offen lds
    ds_read_b128 v[132:135], v35 offset:49152
    ds_read_b128 v[136:139], v31 offset:49152
    ds_read_b128 v[140:143], v31 offset:53248
    v_mfma_f32_32x32x16_bf16 v[80:95], v[168:171], v[176:179], v[80:95]
    s_add_u32 m0, s14, 25600
    s_nop 0
    buffer_load_dwordx4 v17, s[60:63], s15 offen lds
    v_mfma_f32_32x32x16_bf16 v[64:79], v[180:183], v[184:187], v[64:79]
    v_mfma_f32_32x32x16_bf16 v[80:95], v[180:183], v[188:191], v[80:95]
    s_waitcnt vmcnt(6) lgkmcnt(0)
    s_barrier
    v_mfma_f32_32x32x16_bf16 v[64:79], v[96:99], v[100:103], v[64:79]
    s_add_u32 s15, s90, 640
    s_and_b32 s15, s15, 1023
    s_add_u32 m0, s13, 49152
    s_nop 0
    buffer_load_dwordx4 v12, s[56:59], s15 offen lds
    v_mfma_f32_32x32x16_bf16 v[80:95], v[96:99], v[104:107], v[80:95]
    s_add_u32 m0, s13, 50176
    s_nop 0
    buffer_load_dwordx4 v13, s[56:59], s15 offen lds
    ds_read_b128 v[144:147], v32 offset:0
    ds_read_b128 v[148:151], v28 offset:0
    ds_read_b128 v[152:155], v28 offset:4096
    v_mfma_f32_32x32x16_bf16 v[64:79], v[108:111], v[112:115], v[64:79]
    s_add_u32 m0, s13, 51200
    s_nop 0
    buffer_load_dwordx4 v14, s[56:59], s15 offen lds
    ds_read_b128 v[156:159], v33 offset:0
    ds_read_b128 v[160:163], v29 offset:0
    ds_read_b128 v[164:167], v29 offset:4096
    v_mfma_f32_32x32x16_bf16 v[80:95], v[108:111], v[116:119], v[80:95]
    s_add_u32 m0, s13, 52224
    s_nop 0
    buffer_load_dwordx4 v15, s[56:59], s15 offen lds
    ds_read_b128 v[168:171], v34 offset:0
    ds_read_b128 v[172:175], v30 offset:0
    ds_read_b128 v[176:179], v30 offset:4096
    v_mfma_f32_32x32x16_bf16 v[64:79], v[120:123], v[124:127], v[64:79]
    s_add_u32 m0, s14, 49152
    s_nop 0
    buffer_load_dwordx4 v16, s[60:63], s15 offen lds
    ds_read_b128 v[180:183], v35 offset:0
    ds_read_b128 v[184:187], v31 offset:0
    ds_read_b128 v[188:191], v31 offset:4096
    v_mfma_f32_32x32x16_bf16 v[80:95], v[120:123], v[128:131], v[80:95]
    s_add_u32 m0, s14, 50176
    s_nop 0
    buffer_load_dwordx4 v17, s[60:63], s15 offen lds
    v_mfma_f32_32x32x16_bf16 v[64:79], v[132:135], v[136:139], v[64:79]
    v_mfma_f32_32x32x16_bf16 v[80:95], v[132:135], v[140:143], v[80:95]
    v_mov_b32 v62, 0
    buffer_load_dword v62, v62, s[80:83], 0 offen sc1
    s_waitcnt vmcnt(7) lgkmcnt(0)
    s_barrier
    v_mfma_f32_32x32x16_bf16 v[64:79], v[144:147], v[148:151], v[64:79]
    s_add_u32 s15, s90, 768
    s_and_b32 s15, s15, 1023
    s_add_u32 m0, s13, 0
    s_nop 0
    buffer_load_dwordx4 v12, s[56:59], s15 offen lds
    v_mfma_f32_32x32x16_bf16 v[80:95], v[144:147], v[152:155], v[80:95]
    s_add_u32 m0, s13, 1024
    s_nop 0
    buffer_load_dwordx4 v13, s[56:59], s15 offen lds
    ds_read_b128 v[96:99], v32 offset:24576
    ds_read_b128 v[100:103], v28 offset:24576
    ds_read_b128 v[104:107], v28 offset:28672
    v_mfma_f32_32x32x16_bf16 v[64:79], v[156:159], v[160:163], v[64:79]
    s_add_u32 m0, s13, 2048
    s_nop 0
    buffer_load_dwordx4 v14, s[56:59], s15 offen lds
    ds_read_b128 v[108:111], v33 offset:24576
    ds_read_b128 v[112:115], v29 offset:24576
    ds_read_b128 v[116:119], v29 offset:28672
    v_mfma_f32_32x32x16_bf16 v[80:95], v[156:159], v[164:167], v[80:95]
    s_add_u32 m0, s13, 3072
    s_nop 0
    buffer_load_dwordx4 v15, s[56:59], s15 offen lds
    ds_read_b128 v[120:123], v34 offset:24576
    ds_read_b128 v[124:127], v30 offset:24576
    ds_read_b128 v[128:131], v30 offset:28672
    v_mfma_f32_32x32x16_bf16 v[64:79], v[168:171], v[172:175], v[64:79]
    s_add_u32 m0, s14, 0
    s_nop 0
    buffer_load_dwordx4 v16, s[60:63], s15 offen lds
    ds_read_b128 v[132:135], v35 offset:24576
    ds_read_b128 v[136:139], v31 offset:24576
    ds_read_b128 v[140:143], v31 offset:28672
    v_mfma_f32_32x32x16_bf16 v[80:95], v[168:171], v[176:179], v[80:95]
    s_add_u32 m0, s14, 1024
    s_nop 0
    buffer_load_dwordx4 v17, s[60:63], s15 offen lds
    v_mfma_f32_32x32x16_bf16 v[64:79], v[180:183], v[184:187], v[64:79]
    v_mfma_f32_32x32x16_bf16 v[80:95], v[180:183], v[188:191], v[80:95]
    s_waitcnt vmcnt(6) lgkmcnt(0)
    s_barrier
    v_mfma_f32_32x32x16_bf16 v[64:79], v[96:99], v[100:103], v[64:79]
    s_add_u32 s15, s90, 896
    s_and_b32 s15, s15, 1023
    s_add_u32 m0, s13, 24576
    s_nop 0
    buffer_load_dwordx4 v12, s[56:59], s15 offen lds
    v_mfma_f32_32x32x16_bf16 v[80:95], v[96:99], v[104:107], v[80:95]
    s_add_u32 m0, s13, 25600
    s_nop 0
    buffer_load_dwordx4 v13, s[56:59], s15 offen lds
    ds_read_b128 v[144:147], v32 offset:49152
    ds_read_b128 v[148:151], v28 offset:49152
    ds_read_b128 v[152:155], v28 offset:53248
    v_mfma_f32_32x32x16_bf16 v[64:79], v[108:111], v[112:115], v[64:79]
    s_add_u32 m0, s13, 26624
    s_nop 0
    buffer_load_dwordx4 v14, s[56:59], s15 offen lds
    ds_read_b128 v[156:159], v33 offset:49152
    ds_read_b128 v[160:163], v29 offset:49152
    ds_read_b128 v[164:167], v29 offset:53248
    v_mfma_f32_32x32x16_bf16 v[80:95], v[108:111], v[116:119], v[80:95]
    s_add_u32 m0, s13, 27648
    s_nop 0
    buffer_load_dwordx4 v15, s[56:59], s15 offen lds
    ds_read_b128 v[168:171], v34 offset:49152
    ds_read_b128 v[172:175], v30 offset:49152
    ds_read_b128 v[176:179], v30 offset:53248
    v_mfma_f32_32x32x16_bf16 v[64:79], v[120:123], v[124:127], v[64:79]
    s_add_u32 m0, s14, 24576
    s_nop 0
    buffer_load_dwordx4 v16, s[60:63], s15 offen lds
    ds_read_b128 v[180:183], v35 offset:49152
    ds_read_b128 v[184:187], v31 offset:49152
    ds_read_b128 v[188:191], v31 offset:53248
    v_mfma_f32_32x32x16_bf16 v[80:95], v[120:123], v[128:131], v[80:95]
    s_add_u32 m0, s14, 25600
    s_nop 0
    buffer_load_dwordx4 v17, s[60:63], s15 offen lds
    v_mfma_f32_32x32x16_bf16 v[64:79], v[132:135], v[136:139], v[64:79]
    v_mfma_f32_32x32x16_bf16 v[80:95], v[132:135], v[140:143], v[80:95]
G_NL:
    v_readfirstlane_b32 s99, v62
    s_cmp_lg_u32 s99, 0
    s_cbranch_scc1 G_NOK
    s_sleep 2
    v_mov_b32 v62, 0
    buffer_load_dword v62, v62, s[80:83], 0 offen sc1
    s_waitcnt vmcnt(0)
    s_branch G_NL
G_NOK:
    s_setprio 3
    s_waitcnt vmcnt(6) lgkmcnt(0)
    s_barrier
    v_mfma_f32_32x32x16_bf16 v[64:79], v[144:147], v[148:151], v[64:79]
    v_lshlrev_b32 v20, 16, v20
    v_lshlrev_b32 v21, 16, v21
    v_lshlrev_b32 v22, 16, v22
    v_mul_f32 v22, 0x3fb8aa3b, v22
    v_exp_f32 v22, v22
    s_nop 0
    v_mfma_f32_32x32x16_bf16 v[80:95], v[144:147], v[152:155], v[80:95]
    ds_read_b128 v[96:99], v32 offset:0
    ds_read_b128 v[100:103], v28 offset:0
    ds_read_b128 v[104:107], v28 offset:4096
    v_cvt_pk_bf16_f32 v22, v22, v22
    v_and_b32 v22, 0xffff0000, v22
    v_mul_f32 v36, v22, v20
    v_mul_f32 v37, v22, v21
    v_mul_f32 v36, 0x3fb8aa3b, v36
    v_mul_f32 v37, 0x3e22f983, v37
    v_mfma_f32_32x32x16_bf16 v[64:79], v[156:159], v[160:163], v[64:79]
    ds_read_b128 v[108:111], v33 offset:0
    ds_read_b128 v[112:115], v29 offset:0
    ds_read_b128 v[116:119], v29 offset:4096
    v_mul_f32 v38, 1.0, v36
    v_mul_f32 v39, 1.0, v37
    v_exp_f32 v38, v38
    v_fract_f32 v39, v39
    v_cos_f32 v40, v39
    v_sin_f32 v41, v39
    v_mfma_f32_32x32x16_bf16 v[80:95], v[156:159], v[164:167], v[80:95]
    ds_read_b128 v[120:123], v34 offset:0
    ds_read_b128 v[124:127], v30 offset:0
    ds_read_b128 v[128:131], v30 offset:4096
    s_nop 0
    v_mul_f32 v40, v38, v40
    v_mul_f32 v41, v38, v41
    v_mul_f32 v38, 0x41000000, v36
    v_mul_f32 v39, 0x41000000, v37
    v_exp_f32 v38, v38
    v_mfma_f32_32x32x16_bf16 v[64:79], v[168:171], v[172:175], v[64:79]
    ds_read_b128 v[132:135], v35 offset:0
    ds_read_b128 v[136:139], v31 offset:0
    ds_read_b128 v[140:143], v31 offset:4096
    v_fract_f32 v39, v39
    v_cos_f32 v42, v39
    v_sin_f32 v43, v39
    s_nop 0
    v_mul_f32 v42, v38, v42
    v_mul_f32 v43, v38, v43
    v_mfma_f32_32x32x16_bf16 v[80:95], v[168:171], v[176:179], v[80:95]
    v_mul_f32 v38, 0x41800000, v36
    v_mul_f32 v39, 0x41800000, v37
    v_exp_f32 v38, v38
    v_fract_f32 v39, v39
    v_cos_f32 v8, v39
    v_sin_f32 v9, v39
    v_mfma_f32_32x32x16_bf16 v[64:79], v[180:183], v[184:187], v[64:79]
    s_nop 0
    v_mul_f32 v8, v38, v8
    v_mul_f32 v9, v38, v9
    s_lshl_b32 s8, s3, 2
    s_sub_u32 s8, 15, s8
    v_sub_u32 v10, s8, v2
    v_mfma_f32_32x32x16_bf16 v[80:95], v[180:183], v[188:191], v[80:95]
    v_lshlrev_b32 v10, 7, v10
    v_cvt_f32_u32 v10, v10
    v_mul_f32 v38, v10, v36
    v_mul_f32 v39, v10, v37
    v_exp_f32 v38, v38
    v_fract_f32 v39, v39
    s_waitcnt vmcnt(0) lgkmcnt(0)
    s_barrier
    v_mfma_f32_32x32x16_bf16 v[64:79], v[96:99], v[100:103], v[64:79]
    v_cos_f32 v44, v39
    v_sin_f32 v45, v39
    s_nop 0
    v_mul_f32 v44, v38, v44
    v_mul_f32 v45, v38, v45
    v_add_f32 v10, 0xc3800000, v10
    v_mfma_f32_32x32x16_bf16 v[80:95], v[96:99], v[104:107], v[80:95]
    ds_read_b128 v[144:147], v32 offset:24576
    ds_read_b128 v[148:151], v28 offset:24576
    ds_read_b128 v[152:155], v28 offset:28672
    v_mul_f32 v38, v10, v36
    v_mul_f32 v39, v10, v37
    v_exp_f32 v38, v38
    v_fract_f32 v39, v39
    v_cos_f32 v46, v39
    v_sin_f32 v47, v39
    v_mfma_f32_32x32x16_bf16 v[64:79], v[108:111], v[112:115], v[64:79]
    ds_read_b128 v[156:159], v33 offset:24576
    ds_read_b128 v[160:163], v29 offset:24576
    ds_read_b128 v[164:167], v29 offset:28672
    s_nop 0
    v_mul_f32 v46, v38, v46
    v_mul_f32 v47, v38, v47
    v_lshrrev_b32 v10, 5, v0
    v_lshlrev_b32 v10, 4, v10
    v_cvt_f32_u32 v10, v10
    v_mfma_f32_32x32x16_bf16 v[80:95], v[108:111], v[116:119], v[80:95]
    ds_read_b128 v[168:171], v34 offset:24576
    ds_read_b128 v[172:175], v30 offset:24576
    ds_read_b128 v[176:179], v30 offset:28672
    v_mul_f32 v38, v10, v36
    v_mul_f32 v39, v10, v37
    v_exp_f32 v38, v38
    v_fract_f32 v39, v39
    v_cos_f32 v48, v39
    v_sin_f32 v49, v39
    v_mfma_f32_32x32x16_bf16 v[64:79], v[120:123], v[124:127], v[64:79]
    ds_read_b128 v[180:183], v35 offset:24576
    ds_read_b128 v[184:187], v31 offset:24576
    ds_read_b128 v[188:191], v31 offset:28672
    s_nop 0
    v_mul_f32 v48, v38, v48
    v_mul_f32 v49, v38, v49
    v_mul_f32 v38, v20, v20
    v_fmac_f32 v38, v21, v21
    v_rcp_f32 v38, v38
    v_mfma_f32_32x32x16_bf16 v[80:95], v[120:123], v[128:131], v[80:95]
    v_add_f32 v52, -1.0, v40
    v_mov_b32 v53, v41
    v_add_f32 v38, v38, v38
    v_mul_f32 v54, v20, v38
    v_mul_f32 v55, v21, v38
    v_sub_f32 v55, 0, v55
    v_mfma_f32_32x32x16_bf16 v[64:79], v[132:135], v[136:139], v[64:79]
    v_mul_f32 v50, v52, v54
    v_mul_f32 v51, v52, v55
    v_fma_f32 v50, v53, -v55, v50
    v_fmac_f32 v51, v53, v54
    v_bfe_u32 v19, v1, 2, 1
    v_and_b32 v10, 3, v1
    v_mfma_f32_32x32x16_bf16 v[80:95], v[132:135], v[140:143], v[80:95]
    v_lshlrev_b32 v10, 7, v10
    v_lshl_add_u32 v19, v19, 11, v10
    v_bfe_u32 v57, v1, 4, 1
    v_and_b32 v10, 15, v1
    v_lshlrev_b32 v10, 7, v10
    v_lshl_add_u32 v57, v57, 13, v10
    s_waitcnt lgkmcnt(0)
    v_mfma_f32_32x32x16_bf16 v[64:79], v[144:147], v[148:151], v[64:79]
    s_lshl_b32 s91, s89, 14
    s_lshl_b32 s8, s3, 11
    s_add_u32 s91, s91, s8
    s_add_u32 s91, s91, 7864320
    s_lshl_b32 s8, s89, 17
    s_add_u32 s8, s8, 4194304
    v_mfma_f32_32x32x16_bf16 v[80:95], v[144:147], v[152:155], v[80:95]
    s_add_u32 s64, s54, s8
    s_addc_u32 s65, s55, 0
    s_mov_b32 s66, 131072
    s_mov_b32 s67, 0x20000
    s_lshl_b32 s8, s3, 14
    v_lshl_add_u32 v6, v1, 4, s8
    v_mfma_f32_32x32x16_bf16 v[64:79], v[156:159], v[160:163], v[64:79]
    s_and_b32 s8, s3, 1
    s_lshl_b32 s8, s8, 16
    v_add_u32 v6, s8, v6
    v_xor_b32 v7, 0x10000, v6
    v_mfma_f32_32x32x16_bf16 v[80:95], v[156:159], v[164:167], v[80:95]
    v_mfma_f32_32x32x16_bf16 v[64:79], v[168:171], v[172:175], v[64:79]
    v_mfma_f32_32x32x16_bf16 v[80:95], v[168:171], v[176:179], v[80:95]
    v_mfma_f32_32x32x16_bf16 v[64:79], v[180:183], v[184:187], v[64:79]
    v_mfma_f32_32x32x16_bf16 v[80:95], v[180:183], v[188:191], v[80:95]
    s_nop 1
    v_lshlrev_b32 v56, 4, v0
    ds_write_b128 v56, v[24:27] offset:49152
    v_lshrrev_b32 v56, 5, v0
    v_lshlrev_b32 v56, 8, v56
    v_lshl_add_u32 v56, v3, 3, v56
    s_nop 7
    v_fma_f32 v96, v40, v64, v66
    v_fma_f32 v97, v40, v65, v67
    v_fma_f32 v98, v40, v80, v82
    v_fma_f32 v99, v40, v81, v83
    v_fma_f32 v96, -v41, v80, v96
    v_fma_f32 v97, -v41, v81, v97
    v_fmac_f32 v98, v41, v64
    v_fmac_f32 v99, v41, v65
    v_fma_f32 v100, v40, v96, v68
    v_fma_f32 v101, v40, v97, v69
    v_fma_f32 v102, v40, v98, v84
    v_fma_f32 v103, v40, v99, v85
    v_fma_f32 v100, -v41, v98, v100
    v_fma_f32 v101, -v41, v99, v101
    v_fmac_f32 v102, v41, v96
    v_fmac_f32 v103, v41, v97
    v_fma_f32 v96, v40, v100, v70
    v_fma_f32 v97, v40, v101, v71
    v_fma_f32 v98, v40, v102, v86
    v_fma_f32 v99, v40, v103, v87
    v_fma_f32 v96, -v41, v102, v96
    v_fma_f32 v97, -v41, v103, v97
    v_fmac_f32 v98, v41, v100
    v_fmac_f32 v99, v41, v101
    v_fma_f32 v100, v40, v96, v72
    v_fma_f32 v101, v40, v97, v73
    v_fma_f32 v102, v40, v98, v88
    v_fma_f32 v103, v40, v99, v89
    v_fma_f32 v100, -v41, v98, v100
    v_fma_f32 v101, -v41, v99, v101
    v_fmac_f32 v102, v41, v96
    v_fmac_f32 v103, v41, v97
    v_fma_f32 v96, v40, v100, v74
    v_fma_f32 v97, v40, v101, v75
    v_fma_f32 v98, v40, v102, v90
    v_fma_f32 v99, v40, v103, v91
    v_fma_f32 v96, -v41, v102, v96
    v_fma_f32 v97, -v41, v103, v97
    v_fmac_f32 v98, v41, v100
    v_fmac_f32 v99, v41, v101
    v_fma_f32 v100, v40, v96, v76
    v_fma_f32 v101, v40, v97, v77
    v_fma_f32 v102, v40, v98, v92
    v_fma_f32 v103, v40, v99, v93
    v_fma_f32 v100, -v41, v98, v100
    v_fma_f32 v101, -v41, v99, v101
    v_fmac_f32 v102, v41, v96
    v_fmac_f32 v103, v41, v97
    v_fma_f32 v96, v40, v100, v78
    v_fma_f32 v97, v40, v101, v79
    v_fma_f32 v98, v40, v102, v94
    v_fma_f32 v99, v40, v103, v95
    v_fma_f32 v96, -v41, v102, v96
    v_fma_f32 v97, -v41, v103, v97
    v_fmac_f32 v98, v41, v100
    v_fmac_f32 v99, v41, v101
    v_mov_b32 v58, v96
    v_mov_b32 v59, v98
    v_mov_b32 v60, v97
    v_mov_b32 v61, v99
    v_fmac_f32 v60, v42, v58
    v_fmac_f32 v61, v42, v59
    v_fma_f32 v60, v43, -v59, v60
    v_fmac_f32 v61, v43, v58
    ds_write_b64 v56, v[60:61] offset:53248
    s_waitcnt lgkmcnt(0)
    s_barrier
    ds_read_b64 v[110:111], v56 offset:51456
    ds_read_b64 v[112:113], v56 offset:51712
    ds_read_b64 v[114:115], v56 offset:51968
    ds_read_b64 v[116:117], v56 offset:52224
    ds_read_b64 v[118:119], v56 offset:52480
    ds_read_b64 v[120:121], v56 offset:52736
    ds_read_b64 v[122:123], v56 offset:52992
    s_waitcnt lgkmcnt(5)
    v_fmac_f32 v112, v8, v110
    v_fmac_f32 v113, v8, v111
    v_fma_f32 v112, v9, -v111, v112
    v_fmac_f32 v113, v9, v110
    s_waitcnt lgkmcnt(4)
    v_fmac_f32 v114, v8, v112
    v_fmac_f32 v115, v8, v113
    v_fma_f32 v114, v9, -v113, v114
    v_fmac_f32 v115, v9, v112
    s_waitcnt lgkmcnt(3)
    v_fmac_f32 v116, v8, v114
    v_fmac_f32 v117, v8, v115
    v_fma_f32 v116, v9, -v115, v116
    v_fmac_f32 v117, v9, v114
    s_waitcnt lgkmcnt(2)
    v_fmac_f32 v118, v8, v116
    v_fmac_f32 v119, v8, v117
    v_fma_f32 v118, v9, -v117, v118
    v_fmac_f32 v119, v9, v116
    s_waitcnt lgkmcnt(1)
    v_fmac_f32 v120, v8, v118
    v_fmac_f32 v121, v8, v119
    v_fma_f32 v120, v9, -v119, v120
    v_fmac_f32 v121, v9, v118
    s_waitcnt lgkmcnt(0)
    v_fmac_f32 v122, v8, v120
    v_fmac_f32 v123, v8, v121
    v_fma_f32 v122, v9, -v121, v122
    v_fmac_f32 v123, v9, v120
    v_fmac_f32 v60, v8, v122
    v_fmac_f32 v61, v8, v123
    v_fma_f32 v60, v9, -v123, v60
    v_fmac_f32 v61, v9, v122
    v_mov_b32 v24, v60
    v_mov_b32 v25, s99
    v_mov_b32 v26, v61
    v_mov_b32 v27, s99
    buffer_store_dwordx4 v[24:27], v18, s[76:79], 0 offen sc1
    v_fmac_f32 v58, v42, v122
    v_fmac_f32 v59, v42, v123
    v_fma_f32 v58, v43, -v123, v58
    v_fmac_f32 v59, v43, v122
    s_lshl_b32 s8, s4, 9
    s_lshl_b32 s9, s3, 11
    s_add_u32 s8, s8, s9
    s_sub_u32 s8, s8, 8192
    v_lshl_add_u32 v12, v1, 4, s8
    v_add_u32 v13, 1024, v12
    v_mul_f32 v96, v51, v80
    v_mul_f32 v97, v51, v81
    v_mul_f32 v80, v50, v80
    v_mul_f32 v81, v50, v81
    v_fmac_f32 v80, v51, v64
    v_fmac_f32 v81, v51, v65
    v_fma_f32 v64, v50, v64, -v96
    v_fma_f32 v65, v50, v65, -v97
    v_mul_f32 v96, v51, v82
    v_mul_f32 v97, v51, v83
    v_mul_f32 v82, v50, v82
    v_mul_f32 v83, v50, v83
    v_fmac_f32 v82, v51, v66
    v_fmac_f32 v83, v51, v67
    v_fma_f32 v66, v50, v66, -v96
    v_fma_f32 v67, v50, v67, -v97
    v_mul_f32 v96, v51, v84
    v_mul_f32 v97, v51, v85
    v_mul_f32 v84, v50, v84
    v_mul_f32 v85, v50, v85
    v_fmac_f32 v84, v51, v68
    v_fmac_f32 v85, v51, v69
    v_fma_f32 v68, v50, v68, -v96
    v_fma_f32 v69, v50, v69, -v97
    v_mul_f32 v96, v51, v86
    v_mul_f32 v97, v51, v87
    v_mul_f32 v86, v50, v86
    v_mul_f32 v87, v50, v87
    v_fmac_f32 v86, v51, v70
    v_fmac_f32 v87, v51, v71
    v_fma_f32 v70, v50, v70, -v96
    v_fma_f32 v71, v50, v71, -v97
    v_mul_f32 v96, v51, v88
    v_mul_f32 v97, v51, v89
    v_mul_f32 v88, v50, v88
    v_mul_f32 v89, v50, v89
    v_fmac_f32 v88, v51, v72
    v_fmac_f32 v89, v51, v73
    v_fma_f32 v72, v50, v72, -v96
    v_fma_f32 v73, v50, v73, -v97
    v_mul_f32 v96, v51, v90
    v_mul_f32 v97, v51, v91
    v_mul_f32 v90, v50, v90
    v_mul_f32 v91, v50, v91
    v_fmac_f32 v90, v51, v74
    v_fmac_f32 v91, v51, v75
    v_fma_f32 v74, v50, v74, -v96
    v_fma_f32 v75, v50, v75, -v97
    v_mul_f32 v96, v51, v92
    v_mul_f32 v97, v51, v93
    v_mul_f32 v92, v50, v92
    v_mul_f32 v93, v50, v93
    v_fmac_f32 v92, v51, v76
    v_fmac_f32 v93, v51, v77
    v_fma_f32 v76, v50, v76, -v96
    v_fma_f32 v77, v50, v77, -v97
    v_mul_f32 v96, v51, v94
    v_mul_f32 v97, v51, v95
    v_mul_f32 v94, v50, v94
    v_mul_f32 v95, v50, v95
    v_fmac_f32 v94, v51, v78
    v_fmac_f32 v95, v51, v79
    v_fma_f32 v78, v50, v78, -v96
    v_fma_f32 v79, v50, v79, -v97
    v_lshlrev_b32 v14, 3, v0
    v_lshlrev_b32 v15, 3, v3
    v_mul_f32 v100, v50, v122
    v_mul_f32 v101, v50, v123
    v_fma_f32 v100, v51, -v123, v100
    v_fmac_f32 v101, v51, v122
    v_mul_f32 v102, v50, v58
    v_mul_f32 v103, v50, v59
    v_fma_f32 v102, v51, -v59, v102
    v_fmac_f32 v103, v51, v58
    v_mul_f32 v104, v50, v48
    v_mul_f32 v105, v50, v49
    v_fma_f32 v104, v51, -v49, v104
    v_fmac_f32 v105, v51, v48
    v_mul_f32 v106, v104, v42
    v_mul_f32 v107, v104, v43
    v_fma_f32 v106, v105, -v43, v106
    v_fmac_f32 v107, v105, v42
    v_lshrrev_b32 v56, 5, v0
    v_mul_u32_u24 v56, 2304, v56
    v_lshl_add_u32 v56, v3, 2, v56
    v_lshl_or_b32 v16, v5, 3, v4
    v_and_b32 v17, 1, v1
    v_lshl_add_u32 v16, v16, 3, v17
    s_lshl_b32 s12, s3, 1
    s_sub_u32 s12, 6, s12
    v_add_u32 v16, s12, v16
    v_mul_u32_u24 v16, 144, v16
    v_lshl_add_u32 v16, v2, 4, v16
    s_lshl_b32 s12, s3, 16
    s_lshl_b32 s9, s5, 12
    s_add_u32 s12, s12, s9
    v_lshlrev_b32 v17, 4, v1
    s_lshl_b32 s8, s4, 13
    s_add_u32 s8, s8, 7602176
    s_lshl_b32 s7, s3, 11
    s_add_u32 s7, s7, s8
    s_lshl_b32 s10, s5, 7
    s_add_u32 s7, s7, s10
    s_lshl_b32 s10, s88, 12
    s_add_u32 s90, s8, s10
    s_lshl_b32 s10, s3, 9
    s_add_u32 s90, s90, s10
    v_mov_b32 v9, v19
    s_lshl_b32 s8, s4, 18
    s_lshl_b32 s9, s88, 17
    s_add_u32 s8, s8, s9
    s_add_u32 s56, s54, s8
    s_addc_u32 s57, s55, 0
    s_mov_b32 s58, 131072
    s_mov_b32 s59, 0x20000
    s_mov_b32 s68, s16
    s_mov_b32 s69, s17
    s_mov_b32 s70, 2097152
    s_mov_b32 s71, 0x20000
    s_mov_b32 s72, s28
    s_mov_b32 s73, s29
    s_mov_b32 s74, 1024
    s_mov_b32 s75, 0x20000
    s_mov_b32 s80, s50
    s_mov_b32 s81, s51
    s_mov_b32 s82, 4194304
    s_mov_b32 s83, 0x20000
    buffer_load_dwordx4 v[128:131], v12, s[76:79], 0 offen sc1
    buffer_load_dwordx4 v[132:135], v13, s[76:79], 0 offen sc1
G_POLL:
    s_waitcnt vmcnt(0)
    v_mov_b32 v10, 0
    v_ashrrev_i32 v11, 31, v12
    v_xor_b32 v129, s99, v129
    v_xor_b32 v131, s99, v131
    v_or_b32 v129, v129, v131
    v_bfi_b32 v11, v11, 0, v129
    v_or_b32 v10, v10, v11
    v_ashrrev_i32 v11, 31, v13
    v_xor_b32 v133, s99, v133
    v_xor_b32 v135, s99, v135
    v_or_b32 v133, v133, v135
    v_bfi_b32 v11, v11, 0, v133
    v_or_b32 v10, v10, v11
    v_cmp_ne_u32 vcc, 0, v10
    s_nop 4
    s_cbranch_vccz G_POLL_OK
    buffer_load_dwordx4 v[128:131], v12, s[76:79], 0 offen sc1
    buffer_load_dwordx4 v[132:135], v13, s[76:79], 0 offen sc1
    s_branch G_POLL
G_POLL_OK:
    v_mov_b32 v129, v130
    v_mov_b32 v133, v134
    v_mul_f32 v96, v44, v128
    v_mul_f32 v97, v44, v129
    v_fma_f32 v96, v45, -v129, v96
    v_fmac_f32 v97, v45, v128
    v_fmac_f32 v96, v46, v132
    v_fmac_f32 v97, v46, v133
    v_fma_f32 v96, v47, -v133, v96
    v_fmac_f32 v97, v47, v132
    ds_write_b64 v14, v[96:97] offset:57344
    s_waitcnt lgkmcnt(0)
    s_barrier
    buffer_load_dword v23, v57, s[92:95], s91 offen sc1
    ds_read_b64 v[128:129], v15 offset:57344
    ds_read_b64 v[130:131], v15 offset:57600
    ds_read_b64 v[132:133], v15 offset:57856
    ds_read_b64 v[134:135], v15 offset:58112
    ds_read_b64 v[136:137], v15 offset:58368
    ds_read_b64 v[138:139], v15 offset:58624
    ds_read_b64 v[140:141], v15 offset:58880
    ds_read_b64 v[142:143], v15 offset:59136
    s_waitcnt lgkmcnt(0)
    v_add_f32 v128, v128, v136
    v_add_f32 v129, v129, v137
    v_add_f32 v130, v130, v138
    v_add_f32 v131, v131, v139
    v_add_f32 v132, v132, v140
    v_add_f32 v133, v133, v141
    v_add_f32 v134, v134, v142
    v_add_f32 v135, v135, v143
    v_add_f32 v128, v128, v132
    v_add_f32 v129, v129, v133
    v_add_f32 v130, v130, v134
    v_add_f32 v131, v131, v135
    v_add_f32 v128, v128, v130
    v_add_f32 v129, v129, v131
    v_fmac_f32 v100, v104, v128
    v_fmac_f32 v101, v104, v129
    v_fma_f32 v100, v105, -v129, v100
    v_fmac_f32 v101, v105, v128
    v_fmac_f32 v102, v106, v128
    v_fmac_f32 v103, v106, v129
    v_fma_f32 v102, v107, -v129, v102
    v_fmac_f32 v103, v107, v128
    v_mov_b32 v96, v100
    v_mov_b32 v97, v102
    v_mov_b32 v98, v101
    v_mov_b32 v99, v103
    v_fma_f32 v104, v40, v96, v64
    v_fma_f32 v105, v40, v97, v65
    v_fma_f32 v106, v40, v98, v80
    v_fma_f32 v107, v40, v99, v81
    v_fma_f32 v104, -v41, v98, v104
    v_fma_f32 v105, -v41, v99, v105
    v_fmac_f32 v106, v41, v96
    v_fmac_f32 v107, v41, v97
    v_cvt_pk_bf16_f32 v112, v104, -v106
    v_cvt_pk_bf16_f32 v113, v105, -v107
    ds_write_b32 v56, v112 offset:0
    ds_write_b32 v56, v113 offset:1152
    v_fma_f32 v108, v40, v104, v66
    v_fma_f32 v109, v40, v105, v67
    v_fma_f32 v110, v40, v106, v82
    v_fma_f32 v111, v40, v107, v83
    v_fma_f32 v108, -v41, v106, v108
    v_fma_f32 v109, -v41, v107, v109
    v_fmac_f32 v110, v41, v104
    v_fmac_f32 v111, v41, v105
    v_cvt_pk_bf16_f32 v114, v108, -v110
    v_cvt_pk_bf16_f32 v115, v109, -v111
    ds_write_b32 v56, v114 offset:144
    ds_write_b32 v56, v115 offset:1296
    v_fma_f32 v104, v40, v108, v68
    v_fma_f32 v105, v40, v109, v69
    v_fma_f32 v106, v40, v110, v84
    v_fma_f32 v107, v40, v111, v85
    v_fma_f32 v104, -v41, v110, v104
    v_fma_f32 v105, -v41, v111, v105
    v_fmac_f32 v106, v41, v108
    v_fmac_f32 v107, v41, v109
    v_cvt_pk_bf16_f32 v112, v104, -v106
    v_cvt_pk_bf16_f32 v113, v105, -v107
    ds_write_b32 v56, v112 offset:288
    ds_write_b32 v56, v113 offset:1440
    v_fma_f32 v108, v40, v104, v70
    v_fma_f32 v109, v40, v105, v71
    v_fma_f32 v110, v40, v106, v86
    v_fma_f32 v111, v40, v107, v87
    v_fma_f32 v108, -v41, v106, v108
    v_fma_f32 v109, -v41, v107, v109
    v_fmac_f32 v110, v41, v104
    v_fmac_f32 v111, v41, v105
    v_cvt_pk_bf16_f32 v114, v108, -v110
    v_cvt_pk_bf16_f32 v115, v109, -v111
    ds_write_b32 v56, v114 offset:432
    ds_write_b32 v56, v115 offset:1584
    v_fma_f32 v104, v40, v108, v72
    v_fma_f32 v105, v40, v109, v73
    v_fma_f32 v106, v40, v110, v88
    v_fma_f32 v107, v40, v111, v89
    v_fma_f32 v104, -v41, v110, v104
    v_fma_f32 v105, -v41, v111, v105
    v_fmac_f32 v106, v41, v108
    v_fmac_f32 v107, v41, v109
    v_cvt_pk_bf16_f32 v112, v104, -v106
    v_cvt_pk_bf16_f32 v113, v105, -v107
    ds_write_b32 v56, v112 offset:576
    ds_write_b32 v56, v113 offset:1728
    v_fma_f32 v108, v40, v104, v74
    v_fma_f32 v109, v40, v105, v75
    v_fma_f32 v110, v40, v106, v90
    v_fma_f32 v111, v40, v107, v91
    v_fma_f32 v108, -v41, v106, v108
    v_fma_f32 v109, -v41, v107, v109
    v_fmac_f32 v110, v41, v104
    v_fmac_f32 v111, v41, v105
    v_cvt_pk_bf16_f32 v114, v108, -v110
    v_cvt_pk_bf16_f32 v115, v109, -v111
    ds_write_b32 v56, v114 offset:720
    ds_write_b32 v56, v115 offset:1872
    v_fma_f32 v104, v40, v108, v76
    v_fma_f32 v105, v40, v109, v77
    v_fma_f32 v106, v40, v110, v92
    v_fma_f32 v107, v40, v111, v93
    v_fma_f32 v104, -v41, v110, v104
    v_fma_f32 v105, -v41, v111, v105
    v_fmac_f32 v106, v41, v108
    v_fmac_f32 v107, v41, v109
    v_cvt_pk_bf16_f32 v112, v104, -v106
    v_cvt_pk_bf16_f32 v113, v105, -v107
    ds_write_b32 v56, v112 offset:864
    ds_write_b32 v56, v113 offset:2016
    v_fma_f32 v108, v40, v104, v78
    v_fma_f32 v109, v40, v105, v79
    v_fma_f32 v110, v40, v106, v94
    v_fma_f32 v111, v40, v107, v95
    v_fma_f32 v108, -v41, v106, v108
    v_fma_f32 v109, -v41, v107, v109
    v_fmac_f32 v110, v41, v104
    v_fmac_f32 v111, v41, v105
    v_cvt_pk_bf16_f32 v114, v108, -v110
    v_cvt_pk_bf16_f32 v115, v109, -v111
    ds_write_b32 v56, v114 offset:1008
    ds_write_b32 v56, v115 offset:2160
    s_waitcnt lgkmcnt(0)
    s_barrier
    ds_read_b128 v[96:99], v16 offset:0
    ds_read_b128 v[100:103], v16 offset:32
    ds_read_b128 v[104:107], v16 offset:64
    ds_read_b128 v[108:111], v16 offset:96
    s_waitcnt lgkmcnt(3)
    buffer_store_dwordx4 v[96:99], v17, s[84:87], s12 offen offset:0 sc1
    s_waitcnt lgkmcnt(2)
    buffer_store_dwordx4 v[100:103], v17, s[84:87], s12 offen offset:1024 sc1
    s_waitcnt lgkmcnt(1)
    buffer_store_dwordx4 v[104:107], v17, s[84:87], s12 offen offset:2048 sc1
    s_waitcnt lgkmcnt(0)
    buffer_store_dwordx4 v[108:111], v17, s[84:87], s12 offen offset:3072 sc1
    s_waitcnt vmcnt(4)
GC_FL:
    v_cmp_ne_u32 vcc, s99, v23
    s_nop 4
    s_cbranch_vccz GC_FOK
    buffer_load_dword v23, v57, s[92:95], s91 offen sc1
    s_waitcnt vmcnt(0)
    s_branch GC_FL
GC_FOK:
    s_mov_b32 s15, 0
    buffer_load_dwordx4 v[192:195], v6, s[64:67], s15 offen offset:0 sc1
    buffer_load_dwordx4 v[196:199], v7, s[64:67], s15 offen offset:0 sc1
    buffer_load_dwordx4 v[200:203], v6, s[64:67], s15 offen offset:1024 sc1
    buffer_load_dwordx4 v[204:207], v7, s[64:67], s15 offen offset:1024 sc1
    buffer_load_dwordx4 v[208:211], v6, s[64:67], s15 offen offset:2048 sc1
    buffer_load_dwordx4 v[212:215], v7, s[64:67], s15 offen offset:2048 sc1
    buffer_load_dwordx4 v[216:219], v6, s[64:67], s15 offen offset:3072 sc1
    buffer_load_dwordx4 v[220:223], v7, s[64:67], s15 offen offset:3072 sc1
    s_waitcnt vmcnt(8)
    v_mov_b32 v10, s99
    v_lshlrev_b32 v11, 24, v1
    buffer_store_dword v10, v11, s[92:95], s7 offen sc1
    s_mov_b32 s15, 4096
    buffer_load_dwordx4 v[224:227], v6, s[64:67], s15 offen offset:0 sc1
    buffer_load_dwordx4 v[228:231], v7, s[64:67], s15 offen offset:0 sc1
    buffer_load_dwordx4 v[232:235], v6, s[64:67], s15 offen offset:1024 sc1
    buffer_load_dwordx4 v[236:239], v7, s[64:67], s15 offen offset:1024 sc1
    buffer_load_dwordx4 v[240:243], v6, s[64:67], s15 offen offset:2048 sc1
    buffer_load_dwordx4 v[244:247], v7, s[64:67], s15 offen offset:2048 sc1
    buffer_load_dwordx4 v[248:251], v6, s[64:67], s15 offen offset:3072 sc1
    buffer_load_dwordx4 v[252:255], v7, s[64:67], s15 offen offset:3072 sc1
    s_mov_b32 s15, 8192
    buffer_load_dwordx4 v[128:131], v6, s[64:67], s15 offen offset:0 sc1
    buffer_load_dwordx4 v[132:135], v7, s[64:67], s15 offen offset:0 sc1
    buffer_load_dwordx4 v[136:139], v6, s[64:67], s15 offen offset:1024 sc1
    buffer_load_dwordx4 v[140:143], v7, s[64:67], s15 offen offset:1024 sc1
    buffer_load_dwordx4 v[144:147], v6, s[64:67], s15 offen offset:2048 sc1
    buffer_load_dwordx4 v[148:151], v7, s[64:67], s15 offen offset:2048 sc1
    buffer_load_dwordx4 v[152:155], v6, s[64:67], s15 offen offset:3072 sc1
    buffer_load_dwordx4 v[156:159], v7, s[64:67], s15 offen offset:3072 sc1
    s_mov_b32 s15, 12288
    buffer_load_dwordx4 v[160:163], v6, s[64:67], s15 offen offset:0 sc1
    buffer_load_dwordx4 v[164:167], v7, s[64:67], s15 offen offset:0 sc1
    buffer_load_dwordx4 v[168:171], v6, s[64:67], s15 offen offset:1024 sc1
    buffer_load_dwordx4 v[172:175], v7, s[64:67], s15 offen offset:1024 sc1
    buffer_load_dwordx4 v[176:179], v6, s[64:67], s15 offen offset:2048 sc1
    buffer_load_dwordx4 v[180:183], v7, s[64:67], s15 offen offset:2048 sc1
    buffer_load_dwordx4 v[184:187], v6, s[64:67], s15 offen offset:3072 sc1
    buffer_load_dwordx4 v[188:191], v7, s[64:67], s15 offen offset:3072 sc1
    s_mov_b32 s91, s90
    buffer_load_dword v8, v9, s[92:95], s91 offen sc1
    s_mov_b32 s5, s88
    s_mov_b32 s6, s89
    s_mov_b32 s76, s46
    s_mov_b32 s77, s47
    s_mov_b32 s78, 1024
    s_mov_b32 s79, 0x20000
    s_mul_i32 s13, s3, 12288
    s_add_u32 s13, s13, 20480
    v_lshl_add_u32 v4, v1, 4, s13
    s_lshr_b32 s8, s3, 1
    s_xor_b32 s8, s8, s3
    s_and_b32 s8, s8, 1
    s_lshl_b32 s8, s8, 16
    v_xor_b32 v6, s8, v6
    v_xor_b32 v7, s8, v7
    s_waitcnt vmcnt(0)
GH_FL:
    v_cmp_ne_u32 vcc, s99, v8
    s_nop 4
    s_cbranch_vccz GH_FOK
    buffer_load_dword v8, v9, s[92:95], s91 offen sc1
    s_waitcnt vmcnt(0)
    s_branch GH_FL
GH_FOK:
    s_mov_b32 s15, 0
    buffer_load_dwordx4 v[8:11], v6, s[56:59], s15 offen offset:0 sc1
    buffer_load_dwordx4 v[12:15], v7, s[56:59], s15 offen offset:0 sc1
    buffer_load_dwordx4 v[16:19], v6, s[56:59], s15 offen offset:1024 sc1
    buffer_load_dwordx4 v[20:23], v7, s[56:59], s15 offen offset:1024 sc1
    buffer_load_dwordx4 v[24:27], v6, s[56:59], s15 offen offset:2048 sc1
    buffer_load_dwordx4 v[28:31], v7, s[56:59], s15 offen offset:2048 sc1
    buffer_load_dwordx4 v[32:35], v6, s[56:59], s15 offen offset:3072 sc1
    buffer_load_dwordx4 v[36:39], v7, s[56:59], s15 offen offset:3072 sc1
    s_mov_b32 s15, 4096
    buffer_load_dwordx4 v[40:43], v6, s[56:59], s15 offen offset:0 sc1
    buffer_load_dwordx4 v[44:47], v7, s[56:59], s15 offen offset:0 sc1
    buffer_load_dwordx4 v[48:51], v6, s[56:59], s15 offen offset:1024 sc1
    buffer_load_dwordx4 v[52:55], v7, s[56:59], s15 offen offset:1024 sc1
    buffer_load_dwordx4 v[56:59], v6, s[56:59], s15 offen offset:2048 sc1
    buffer_load_dwordx4 v[60:63], v7, s[56:59], s15 offen offset:2048 sc1
    s_mov_b32 s16, 0
    s_mov_b32 s24, 0
    s_mov_b32 s17, 8192
    s_mov_b32 s25, 16384
    s_mov_b32 s18, 16384
    s_mov_b32 s26, 32768
    s_mov_b32 s19, 24576
    s_mov_b32 s27, 49152
    s_mov_b32 s20, 32768
    s_mov_b32 s28, 65536
    s_mov_b32 s21, 40960
    s_mov_b32 s29, 81920
    s_mov_b32 s22, 49152
    s_mov_b32 s30, 98304
    s_mov_b32 s23, 57344
    s_mov_b32 s31, 114688
    s_waitcnt vmcnt(12)
    v_mfma_f32_32x32x16_bf16 v[64:79], v[8:11], v[192:195], 0
    v_mfma_f32_32x32x16_bf16 v[80:95], v[8:11], v[196:199], 0
    v_mfma_f32_32x32x16_bf16 v[112:127], v[12:15], v[196:199], 0
    v_mfma_f32_32x32x16_bf16 v[96:111], v[12:15], v[192:195], 0
    buffer_load_dwordx4 v[8:11], v6, s[56:59], s15 offen offset:3072 sc1
    buffer_load_dwordx4 v[12:15], v7, s[56:59], s15 offen offset:3072 sc1
    s_waitcnt vmcnt(12)
    v_mfma_f32_32x32x16_bf16 v[64:79], v[16:19], v[200:203], v[64:79]
    v_mfma_f32_32x32x16_bf16 v[80:95], v[16:19], v[204:207], v[80:95]
    v_mfma_f32_32x32x16_bf16 v[112:127], v[20:23], v[204:207], v[112:127]
    v_mfma_f32_32x32x16_bf16 v[96:111], v[20:23], v[200:203], v[96:111]
    s_mov_b32 s15, 8192
    buffer_load_dwordx4 v[16:19], v6, s[56:59], s15 offen offset:0 sc1
    buffer_load_dwordx4 v[20:23], v7, s[56:59], s15 offen offset:0 sc1
    s_waitcnt vmcnt(12)
    v_mfma_f32_32x32x16_bf16 v[64:79], v[24:27], v[208:211], v[64:79]
    v_mfma_f32_32x32x16_bf16 v[80:95], v[24:27], v[212:215], v[80:95]
    v_mfma_f32_32x32x16_bf16 v[112:127], v[28:31], v[212:215], v[112:127]
    v_mfma_f32_32x32x16_bf16 v[96:111], v[28:31], v[208:211], v[96:111]
    buffer_load_dwordx4 v[24:27], v6, s[56:59], s15 offen offset:1024 sc1
    buffer_load_dwordx4 v[28:31], v7, s[56:59], s15 offen offset:1024 sc1
    s_waitcnt vmcnt(12)
    v_mfma_f32_32x32x16_bf16 v[64:79], v[32:35], v[216:219], v[64:79]
    v_mfma_f32_32x32x16_bf16 v[80:95], v[32:35], v[220:223], v[80:95]
    v_mfma_f32_32x32x16_bf16 v[112:127], v[36:39], v[220:223], v[112:127]
    v_mfma_f32_32x32x16_bf16 v[96:111], v[36:39], v[216:219], v[96:111]
    buffer_load_dwordx4 v[32:35], v6, s[56:59], s15 offen offset:2048 sc1
    buffer_load_dwordx4 v[36:39], v7, s[56:59], s15 offen offset:2048 sc1
    s_waitcnt vmcnt(12)
    v_mfma_f32_32x32x16_bf16 v[64:79], v[40:43], v[224:227], v[64:79]
    v_mfma_f32_32x32x16_bf16 v[80:95], v[40:43], v[228:231], v[80:95]
    v_mfma_f32_32x32x16_bf16 v[112:127], v[44:47], v[228:231], v[112:127]
    v_mfma_f32_32x32x16_bf16 v[96:111], v[44:47], v[224:227], v[96:111]
    buffer_load_dwordx4 v[40:43], v6, s[56:59], s15 offen offset:3072 sc1
    buffer_load_dwordx4 v[44:47], v7, s[56:59], s15 offen offset:3072 sc1
    s_waitcnt vmcnt(12)
    v_mfma_f32_32x32x16_bf16 v[64:79], v[48:51], v[232:235], v[64:79]
    v_mfma_f32_32x32x16_bf16 v[80:95], v[48:51], v[236:239], v[80:95]
    v_mfma_f32_32x32x16_bf16 v[112:127], v[52:55], v[236:239], v[112:127]
    v_mfma_f32_32x32x16_bf16 v[96:111], v[52:55], v[232:235], v[96:111]
    s_mov_b32 s15, 12288
    buffer_load_dwordx4 v[48:51], v6, s[56:59], s15 offen offset:0 sc1
    buffer_load_dwordx4 v[52:55], v7, s[56:59], s15 offen offset:0 sc1
    s_waitcnt vmcnt(12)
    v_mfma_f32_32x32x16_bf16 v[64:79], v[56:59], v[240:243], v[64:79]
    v_mfma_f32_32x32x16_bf16 v[80:95], v[56:59], v[244:247], v[80:95]
    v_mfma_f32_32x32x16_bf16 v[112:127], v[60:63], v[244:247], v[112:127]
    v_mfma_f32_32x32x16_bf16 v[96:111], v[60:63], v[240:243], v[96:111]
    buffer_load_dwordx4 v[56:59], v6, s[56:59], s15 offen offset:1024 sc1
    buffer_load_dwordx4 v[60:63], v7, s[56:59], s15 offen offset:1024 sc1
    s_waitcnt vmcnt(12)
    v_mfma_f32_32x32x16_bf16 v[64:79], v[8:11], v[248:251], v[64:79]
    v_mfma_f32_32x32x16_bf16 v[80:95], v[8:11], v[252:255], v[80:95]
    v_mfma_f32_32x32x16_bf16 v[112:127], v[12:15], v[252:255], v[112:127]
    v_mfma_f32_32x32x16_bf16 v[96:111], v[12:15], v[248:251], v[96:111]
    buffer_load_dwordx4 v[8:11], v6, s[56:59], s15 offen offset:2048 sc1
    buffer_load_dwordx4 v[12:15], v7, s[56:59], s15 offen offset:2048 sc1
    s_waitcnt vmcnt(12)
    v_mfma_f32_32x32x16_bf16 v[64:79], v[16:19], v[128:131], v[64:79]
    v_mfma_f32_32x32x16_bf16 v[80:95], v[16:19], v[132:135], v[80:95]
    v_mfma_f32_32x32x16_bf16 v[112:127], v[20:23], v[132:135], v[112:127]
    v_mfma_f32_32x32x16_bf16 v[96:111], v[20:23], v[128:131], v[96:111]
    buffer_load_dwordx4 v[16:19], v6, s[56:59], s15 offen offset:3072 sc1
    buffer_load_dwordx4 v[20:23], v7, s[56:59], s15 offen offset:3072 sc1
    s_lshr_b32 s10, s3, 1
    s_lshl_b32 s8, s5, 1
    s_add_u32 s10, s10, s8
    s_and_b32 s8, s3, 1
    s_lshl_b32 s8, s8, 5
    s_lshl_b32 s9, s6, 6
    s_add_u32 s8, s8, s9
    v_add_u32 v240, s8, v3
    s_lshl_b32 s8, s4, 2
    s_add_u32 s8, s8, s10
    s_and_b32 s11, s8, 32
    s_add_u32 s11, s11, s8
    s_lshl_b32 s11, s11, 5
    s_add_u32 s11, s11, 5242880
    v_lshlrev_b32 v241, 12, v240
    v_lshl_add_u32 v241, v2, 4, v241
    s_lshl_b32 s12, s8, 7
    s_add_u32 s12, s12, 7340032
    v_lshlrev_b32 v242, 6, v2
    v_lshlrev_b32 v243, 1, v240
    s_lshl_b32 s8, s4, 7
    s_lshl_b32 s9, s10, 1
    s_sub_u32 s8, s8, s9
    s_add_u32 s8, s8, 6
    v_lshl_add_u32 v244, v2, 6, s8
    v_xor_b32 v245, 64, v244
    v_lshl_add_u32 v244, v244, 10, v243
    v_lshl_add_u32 v245, v245, 10, v243
    v_lshlrev_b32 v246, 1, v244
    v_lshlrev_b32 v247, 1, v245
    s_lshr_b32 s14, s4, 3
    s_lshl_b32 s14, s14, 16
    s_add_u32 s14, s14, 7733248
    v_lshlrev_b32 v234, 7, v240
    s_waitcnt vmcnt(12)
    v_mfma_f32_32x32x16_bf16 v[64:79], v[24:27], v[136:139], v[64:79]
    buffer_load_dword v235, v234, s[92:95], s14 offen sc1
    v_mfma_f32_32x32x16_bf16 v[80:95], v[24:27], v[140:143], v[80:95]
    buffer_load_dwordx4 v[216:219], v242, s[92:95], s12 offen offset:0 sc1
    v_mfma_f32_32x32x16_bf16 v[112:127], v[28:31], v[140:143], v[112:127]
    buffer_load_dwordx4 v[220:223], v242, s[92:95], s12 offen offset:16 sc1
    v_mfma_f32_32x32x16_bf16 v[96:111], v[28:31], v[136:139], v[96:111]
    buffer_load_dwordx4 v[224:227], v242, s[92:95], s12 offen offset:32 sc1
    s_waitcnt vmcnt(14)
    v_mfma_f32_32x32x16_bf16 v[64:79], v[32:35], v[144:147], v[64:79]
    buffer_load_dwordx4 v[228:231], v242, s[92:95], s12 offen offset:48 sc1
    v_mfma_f32_32x32x16_bf16 v[80:95], v[32:35], v[148:151], v[80:95]
    buffer_load_ushort v232, v243, s[72:75], 0 offen
    v_mfma_f32_32x32x16_bf16 v[112:127], v[36:39], v[148:151], v[112:127]
    buffer_load_ushort v233, v243, s[76:79], 0 offen
    v_mfma_f32_32x32x16_bf16 v[96:111], v[36:39], v[144:147], v[96:111]
    buffer_load_ushort v192, v244, s[68:71], s16 offen offset:0
    s_waitcnt vmcnt(16)
    v_mfma_f32_32x32x16_bf16 v[64:79], v[40:43], v[152:155], v[64:79]
    buffer_load_ushort v193, v244, s[68:71], s16 offen offset:1024
    v_mfma_f32_32x32x16_bf16 v[80:95], v[40:43], v[156:159], v[80:95]
    buffer_load_ushort v194, v244, s[68:71], s17 offen offset:0
    v_mfma_f32_32x32x16_bf16 v[112:127], v[44:47], v[156:159], v[112:127]
    buffer_load_ushort v195, v244, s[68:71], s17 offen offset:1024
    v_mfma_f32_32x32x16_bf16 v[96:111], v[44:47], v[152:155], v[96:111]
    buffer_load_ushort v196, v245, s[68:71], s18 offen offset:0
    s_waitcnt vmcnt(18)
    v_mfma_f32_32x32x16_bf16 v[64:79], v[48:51], v[160:163], v[64:79]
    buffer_load_ushort v197, v245, s[68:71], s18 offen offset:1024
    v_mfma_f32_32x32x16_bf16 v[80:95], v[48:51], v[164:167], v[80:95]
    buffer_load_ushort v198, v245, s[68:71], s19 offen offset:0
    v_mfma_f32_32x32x16_bf16 v[112:127], v[52:55], v[164:167], v[112:127]
    buffer_load_ushort v199, v245, s[68:71], s19 offen offset:1024
    v_mfma_f32_32x32x16_bf16 v[96:111], v[52:55], v[160:163], v[96:111]
    buffer_load_ushort v200, v245, s[68:71], s20 offen offset:0
    s_waitcnt vmcnt(20)
    v_mfma_f32_32x32x16_bf16 v[64:79], v[56:59], v[168:171], v[64:79]
    buffer_load_ushort v201, v245, s[68:71], s20 offen offset:1024
    v_mfma_f32_32x32x16_bf16 v[80:95], v[56:59], v[172:175], v[80:95]
    buffer_load_ushort v202, v245, s[68:71], s21 offen offset:0
    v_mfma_f32_32x32x16_bf16 v[112:127], v[60:63], v[172:175], v[112:127]
    buffer_load_ushort v203, v245, s[68:71], s21 offen offset:1024
    v_mfma_f32_32x32x16_bf16 v[96:111], v[60:63], v[168:171], v[96:111]
    buffer_load_ushort v204, v244, s[68:71], s22 offen offset:0
    s_waitcnt vmcnt(22)
    v_mfma_f32_32x32x16_bf16 v[64:79], v[8:11], v[176:179], v[64:79]
    buffer_load_ushort v205, v244, s[68:71], s22 offen offset:1024
    v_mfma_f32_32x32x16_bf16 v[80:95], v[8:11], v[180:183], v[80:95]
    buffer_load_ushort v206, v244, s[68:71], s23 offen offset:0
    v_mfma_f32_32x32x16_bf16 v[112:127], v[12:15], v[180:183], v[112:127]
    buffer_load_ushort v207, v244, s[68:71], s23 offen offset:1024
    v_mfma_f32_32x32x16_bf16 v[96:111], v[12:15], v[176:179], v[96:111]
    s_waitcnt vmcnt(23)
    v_mfma_f32_32x32x16_bf16 v[64:79], v[16:19], v[184:187], v[64:79]
    v_mfma_f32_32x32x16_bf16 v[80:95], v[16:19], v[188:191], v[80:95]
    v_mfma_f32_32x32x16_bf16 v[112:127], v[20:23], v[188:191], v[112:127]
    v_mfma_f32_32x32x16_bf16 v[96:111], v[20:23], v[184:187], v[96:111]
    s_waitcnt vmcnt(22)
GY_FL:
    v_cmp_ne_u32 vcc, s99, v235
    s_nop 4
    s_cbranch_vccz GY_FOK
    buffer_load_dword v235, v234, s[92:95], s14 offen sc1
    s_waitcnt vmcnt(0)
    s_branch GY_FL
GY_FOK:
    buffer_load_dwordx4 v[208:211], v241, s[92:95], s11 offen sc1
    buffer_load_dwordx4 v[212:215], v241, s[92:95], s11 offen offset:1024 sc1
    s_xor_b32 s8, s3, 1
    s_mul_i32 s8, s8, 12288
    s_add_u32 s8, s8, 20480
    v_lshl_add_u32 v16, v1, 4, s8
    s_xor_b32 s8, s3, 2
    s_mul_i32 s8, s8, 12288
    s_add_u32 s8, s8, 20480
    v_lshl_add_u32 v17, v1, 4, s8
    s_xor_b32 s8, s3, 3
    s_mul_i32 s8, s8, 12288
    s_add_u32 s8, s8, 20480
    v_lshl_add_u32 v18, v1, 4, s8
    s_waitcnt vmcnt(2)
GG_L:
    v_xor_b32 v20, s99, v217
    v_xor_b32 v21, s99, v219
    v_or_b32 v20, v20, v21
    v_xor_b32 v21, s99, v221
    v_or_b32 v20, v20, v21
    v_xor_b32 v21, s99, v223
    v_or_b32 v20, v20, v21
    v_xor_b32 v21, s99, v225
    v_or_b32 v20, v20, v21
    v_xor_b32 v21, s99, v227
    v_or_b32 v20, v20, v21
    v_xor_b32 v21, s99, v229
    v_or_b32 v20, v20, v21
    v_xor_b32 v21, s99, v231
    v_or_b32 v20, v20, v21
    v_cmp_ne_u32 vcc, 0, v20
    s_nop 4
    s_cbranch_vccz GG_OK
    buffer_load_dwordx4 v[216:219], v242, s[92:95], s12 offen offset:0 sc1
    buffer_load_dwordx4 v[220:223], v242, s[92:95], s12 offen offset:16 sc1
    buffer_load_dwordx4 v[224:227], v242, s[92:95], s12 offen offset:32 sc1
    buffer_load_dwordx4 v[228:231], v242, s[92:95], s12 offen offset:48 sc1
    s_waitcnt vmcnt(0)
    s_branch GG_L
GG_OK:
    v_and_b32 v217, 0xffff0000, v216
    v_lshlrev_b32 v216, 16, v216
    v_and_b32 v219, 0xffff0000, v218
    v_lshlrev_b32 v218, 16, v218
    v_and_b32 v221, 0xffff0000, v220
    v_lshlrev_b32 v220, 16, v220
    v_and_b32 v223, 0xffff0000, v222
    v_lshlrev_b32 v222, 16, v222
    v_and_b32 v225, 0xffff0000, v224
    v_lshlrev_b32 v224, 16, v224
    v_and_b32 v227, 0xffff0000, v226
    v_lshlrev_b32 v226, 16, v226
    v_and_b32 v229, 0xffff0000, v228
    v_lshlrev_b32 v228, 16, v228
    v_and_b32 v231, 0xffff0000, v230
    v_lshlrev_b32 v230, 16, v230
    v_lshlrev_b32 v232, 16, v232
    v_lshlrev_b32 v233, 16, v233
    ds_write_b128 v4, v[80:83] offset:4096
    ds_write_b128 v4, v[84:87] offset:5120
    v_lshlrev_b32 v192, 16, v192
    v_lshlrev_b32 v193, 16, v193
    v_pk_mul_f32 v[20:21], v[192:193], v[232:233] op_sel:[0,0] op_sel_hi:[1,0]
    v_pk_mul_f32 v[22:23], v[192:193], v[232:233] op_sel:[0,1] op_sel_hi:[1,1]
    v_cvt_pk_bf16_f32 v20, v20, v21
    v_cvt_pk_bf16_f32 v22, v22, v23
    v_and_b32 v33, 0xffff0000, v20
    v_lshlrev_b32 v32, 16, v20
    v_and_b32 v23, 0xffff0000, v22
    v_lshlrev_b32 v22, 16, v22
    v_pk_add_f32 v[64:65], v[64:65], v[22:23]
    v_sub_f32 v20, 1.0, v216
    v_sub_f32 v21, 1.0, v217
    v_cvt_pk_bf16_f32 v20, v20, v21
    v_and_b32 v193, 0xffff0000, v20
    v_lshlrev_b32 v192, 16, v20
    ds_write_b128 v4, v[88:91] offset:6144
    ds_write_b128 v4, v[92:95] offset:7168
    v_lshlrev_b32 v194, 16, v194
    v_lshlrev_b32 v195, 16, v195
    v_pk_mul_f32 v[20:21], v[194:195], v[232:233] op_sel:[0,0] op_sel_hi:[1,0]
    v_pk_mul_f32 v[22:23], v[194:195], v[232:233] op_sel:[0,1] op_sel_hi:[1,1]
    v_cvt_pk_bf16_f32 v20, v20, v21
    v_cvt_pk_bf16_f32 v22, v22, v23
    v_and_b32 v35, 0xffff0000, v20
    v_lshlrev_b32 v34, 16, v20
    v_and_b32 v23, 0xffff0000, v22
    v_lshlrev_b32 v22, 16, v22
    v_pk_add_f32 v[66:67], v[66:67], v[22:23]
    v_sub_f32 v20, 1.0, v218
    v_sub_f32 v21, 1.0, v219
    v_cvt_pk_bf16_f32 v20, v20, v21
    v_and_b32 v195, 0xffff0000, v20
    v_lshlrev_b32 v194, 16, v20
    ds_write_b128 v4, v[112:115] offset:12288
    ds_write_b128 v4, v[116:119] offset:13312
    v_lshlrev_b32 v196, 16, v196
    v_lshlrev_b32 v197, 16, v197
    v_pk_mul_f32 v[20:21], v[196:197], v[232:233] op_sel:[0,0] op_sel_hi:[1,0]
    v_pk_mul_f32 v[22:23], v[196:197], v[232:233] op_sel:[0,1] op_sel_hi:[1,1]
    v_cvt_pk_bf16_f32 v20, v20, v21
    v_cvt_pk_bf16_f32 v22, v22, v23
    v_and_b32 v37, 0xffff0000, v20
    v_lshlrev_b32 v36, 16, v20
    v_and_b32 v23, 0xffff0000, v22
    v_lshlrev_b32 v22, 16, v22
    v_pk_add_f32 v[68:69], v[68:69], v[22:23]
    v_sub_f32 v20, 1.0, v220
    v_sub_f32 v21, 1.0, v221
    v_cvt_pk_bf16_f32 v20, v20, v21
    v_and_b32 v197, 0xffff0000, v20
    v_lshlrev_b32 v196, 16, v20
    ds_write_b128 v4, v[120:123] offset:14336
    ds_write_b128 v4, v[124:127] offset:15360
    v_lshlrev_b32 v198, 16, v198
    v_lshlrev_b32 v199, 16, v199
    v_pk_mul_f32 v[20:21], v[198:199], v[232:233] op_sel:[0,0] op_sel_hi:[1,0]
    v_pk_mul_f32 v[22:23], v[198:199], v[232:233] op_sel:[0,1] op_sel_hi:[1,1]
    v_cvt_pk_bf16_f32 v20, v20, v21
    v_cvt_pk_bf16_f32 v22, v22, v23
    v_and_b32 v39, 0xffff0000, v20
    v_lshlrev_b32 v38, 16, v20
    v_and_b32 v23, 0xffff0000, v22
    v_lshlrev_b32 v22, 16, v22
    v_pk_add_f32 v[70:71], v[70:71], v[22:23]
    v_sub_f32 v20, 1.0, v222
    v_sub_f32 v21, 1.0, v223
    v_cvt_pk_bf16_f32 v20, v20, v21
    v_and_b32 v199, 0xffff0000, v20
    v_lshlrev_b32 v198, 16, v20
    ds_write_b128 v4, v[96:99] offset:8192
    ds_write_b128 v4, v[100:103] offset:9216
    v_lshlrev_b32 v200, 16, v200
    v_lshlrev_b32 v201, 16, v201
    v_pk_mul_f32 v[20:21], v[200:201], v[232:233] op_sel:[0,0] op_sel_hi:[1,0]
    v_pk_mul_f32 v[22:23], v[200:201], v[232:233] op_sel:[0,1] op_sel_hi:[1,1]
    v_cvt_pk_bf16_f32 v20, v20, v21
    v_cvt_pk_bf16_f32 v22, v22, v23
    v_and_b32 v41, 0xffff0000, v20
    v_lshlrev_b32 v40, 16, v20
    v_and_b32 v23, 0xffff0000, v22
    v_lshlrev_b32 v22, 16, v22
    v_pk_add_f32 v[72:73], v[72:73], v[22:23]
    v_sub_f32 v20, 1.0, v224
    v_sub_f32 v21, 1.0, v225
    v_cvt_pk_bf16_f32 v20, v20, v21
    v_and_b32 v201, 0xffff0000, v20
    v_lshlrev_b32 v200, 16, v20
    ds_write_b128 v4, v[104:107] offset:10240
    ds_write_b128 v4, v[108:111] offset:11264
    v_lshlrev_b32 v202, 16, v202
    v_lshlrev_b32 v203, 16, v203
    v_pk_mul_f32 v[20:21], v[202:203], v[232:233] op_sel:[0,0] op_sel_hi:[1,0]
    v_pk_mul_f32 v[22:23], v[202:203], v[232:233] op_sel:[0,1] op_sel_hi:[1,1]
    v_cvt_pk_bf16_f32 v20, v20, v21
    v_cvt_pk_bf16_f32 v22, v22, v23
    v_and_b32 v43, 0xffff0000, v20
    v_lshlrev_b32 v42, 16, v20
    v_and_b32 v23, 0xffff0000, v22
    v_lshlrev_b32 v22, 16, v22
    v_pk_add_f32 v[74:75], v[74:75], v[22:23]
    v_sub_f32 v20, 1.0, v226
    v_sub_f32 v21, 1.0, v227
    v_cvt_pk_bf16_f32 v20, v20, v21
    v_and_b32 v203, 0xffff0000, v20
    v_lshlrev_b32 v202, 16, v20
    s_waitcnt lgkmcnt(0)
    s_barrier
    ds_read_b128 v[80:83], v16 offset:4096
    ds_read_b128 v[84:87], v16 offset:5120
    ds_read_b128 v[88:91], v16 offset:6144
    ds_read_b128 v[92:95], v16 offset:7168
    ds_read_b128 v[96:99], v17 offset:8192
    ds_read_b128 v[100:103], v17 offset:9216
    ds_read_b128 v[104:107], v17 offset:10240
    ds_read_b128 v[108:111], v17 offset:11264
    ds_read_b128 v[112:115], v18 offset:12288
    ds_read_b128 v[116:119], v18 offset:13312
    ds_read_b128 v[120:123], v18 offset:14336
    ds_read_b128 v[124:127], v18 offset:15360
    v_lshlrev_b32 v204, 16, v204
    v_lshlrev_b32 v205, 16, v205
    v_pk_mul_f32 v[20:21], v[204:205], v[232:233] op_sel:[0,0] op_sel_hi:[1,0]
    v_pk_mul_f32 v[22:23], v[204:205], v[232:233] op_sel:[0,1] op_sel_hi:[1,1]
    v_cvt_pk_bf16_f32 v20, v20, v21
    v_cvt_pk_bf16_f32 v22, v22, v23
    v_and_b32 v45, 0xffff0000, v20
    v_lshlrev_b32 v44, 16, v20
    v_and_b32 v23, 0xffff0000, v22
    v_lshlrev_b32 v22, 16, v22
    v_pk_add_f32 v[76:77], v[76:77], v[22:23]
    v_sub_f32 v20, 1.0, v228
    v_sub_f32 v21, 1.0, v229
    v_cvt_pk_bf16_f32 v20, v20, v21
    v_and_b32 v205, 0xffff0000, v20
    v_lshlrev_b32 v204, 16, v20
    v_lshlrev_b32 v206, 16, v206
    v_lshlrev_b32 v207, 16, v207
    v_pk_mul_f32 v[20:21], v[206:207], v[232:233] op_sel:[0,0] op_sel_hi:[1,0]
    v_pk_mul_f32 v[22:23], v[206:207], v[232:233] op_sel:[0,1] op_sel_hi:[1,1]
    v_cvt_pk_bf16_f32 v20, v20, v21
    v_cvt_pk_bf16_f32 v22, v22, v23
    v_and_b32 v47, 0xffff0000, v20
    v_lshlrev_b32 v46, 16, v20
    v_and_b32 v23, 0xffff0000, v22
    v_lshlrev_b32 v22, 16, v22
    v_pk_add_f32 v[78:79], v[78:79], v[22:23]
    v_sub_f32 v20, 1.0, v230
    v_sub_f32 v21, 1.0, v231
    v_cvt_pk_bf16_f32 v20, v20, v21
    v_and_b32 v207, 0xffff0000, v20
    v_lshlrev_b32 v206, 16, v20
    s_waitcnt vmcnt(0) lgkmcnt(0)
    v_lshlrev_b32 v22, 16, v208
    v_and_b32 v23, 0xffff0000, v208
    v_pk_add_f32 v[64:65], v[64:65], v[80:81]
    v_pk_add_f32 v[20:21], v[32:33], v[22:23]
    v_cvt_pk_bf16_f32 v20, v20, v21
    v_pk_add_f32 v[96:97], v[96:97], v[112:113]
    v_and_b32 v21, 0xffff0000, v20
    v_lshlrev_b32 v20, 16, v20
    v_pk_mul_f32 v[20:21], v[20:21], v[216:217]
    v_pk_add_f32 v[64:65], v[64:65], v[96:97]
    v_cvt_pk_bf16_f32 v20, v20, v21
    v_and_b32 v21, 0xffff0000, v20
    v_lshlrev_b32 v20, 16, v20
    v_pk_fma_f32 v[64:65], v[64:65], v[192:193], v[20:21]
    buffer_store_dword v64, v246, s[80:83], s24 offen offset:0
    buffer_store_dword v65, v246, s[80:83], s24 offen offset:2048
    v_lshlrev_b32 v22, 16, v209
    v_and_b32 v23, 0xffff0000, v209
    v_pk_add_f32 v[66:67], v[66:67], v[82:83]
    v_pk_add_f32 v[20:21], v[34:35], v[22:23]
    v_cvt_pk_bf16_f32 v20, v20, v21
    v_pk_add_f32 v[98:99], v[98:99], v[114:115]
    v_and_b32 v21, 0xffff0000, v20
    v_lshlrev_b32 v20, 16, v20
    v_pk_mul_f32 v[20:21], v[20:21], v[218:219]
    v_pk_add_f32 v[66:67], v[66:67], v[98:99]
    v_cvt_pk_bf16_f32 v20, v20, v21
    v_and_b32 v21, 0xffff0000, v20
    v_lshlrev_b32 v20, 16, v20
    v_pk_fma_f32 v[66:67], v[66:67], v[194:195], v[20:21]
    buffer_store_dword v66, v246, s[80:83], s25 offen offset:0
    buffer_store_dword v67, v246, s[80:83], s25 offen offset:2048
    v_lshlrev_b32 v22, 16, v210
    v_and_b32 v23, 0xffff0000, v210
    v_pk_add_f32 v[68:69], v[68:69], v[84:85]
    v_pk_add_f32 v[20:21], v[36:37], v[22:23]
    v_cvt_pk_bf16_f32 v20, v20, v21
    v_pk_add_f32 v[100:101], v[100:101], v[116:117]
    v_and_b32 v21, 0xffff0000, v20
    v_lshlrev_b32 v20, 16, v20
    v_pk_mul_f32 v[20:21], v[20:21], v[220:221]
    v_pk_add_f32 v[68:69], v[68:69], v[100:101]
    v_cvt_pk_bf16_f32 v20, v20, v21
    v_and_b32 v21, 0xffff0000, v20
    v_lshlrev_b32 v20, 16, v20
    v_pk_fma_f32 v[68:69], v[68:69], v[196:197], v[20:21]
    buffer_store_dword v68, v247, s[80:83], s26 offen offset:0
    buffer_store_dword v69, v247, s[80:83], s26 offen offset:2048
    v_lshlrev_b32 v22, 16, v211
    v_and_b32 v23, 0xffff0000, v211
    v_pk_add_f32 v[70:71], v[70:71], v[86:87]
    v_pk_add_f32 v[20:21], v[38:39], v[22:23]
    v_cvt_pk_bf16_f32 v20, v20, v21
    v_pk_add_f32 v[102:103], v[102:103], v[118:119]
    v_and_b32 v21, 0xffff0000, v20
    v_lshlrev_b32 v20, 16, v20
    v_pk_mul_f32 v[20:21], v[20:21], v[222:223]
    v_pk_add_f32 v[70:71], v[70:71], v[102:103]
    v_cvt_pk_bf16_f32 v20, v20, v21
    v_and_b32 v21, 0xffff0000, v20
    v_lshlrev_b32 v20, 16, v20
    v_pk_fma_f32 v[70:71], v[70:71], v[198:199], v[20:21]
    buffer_store_dword v70, v247, s[80:83], s27 offen offset:0
    buffer_store_dword v71, v247, s[80:83], s27 offen offset:2048
    v_lshlrev_b32 v22, 16, v212
    v_and_b32 v23, 0xffff0000, v212
    v_pk_add_f32 v[72:73], v[72:73], v[88:89]
    v_pk_add_f32 v[20:21], v[40:41], v[22:23]
    v_cvt_pk_bf16_f32 v20, v20, v21
    v_pk_add_f32 v[104:105], v[104:105], v[120:121]
    v_and_b32 v21, 0xffff0000, v20
    v_lshlrev_b32 v20, 16, v20
    v_pk_mul_f32 v[20:21], v[20:21], v[224:225]
    v_pk_add_f32 v[72:73], v[72:73], v[104:105]
    v_cvt_pk_bf16_f32 v20, v20, v21
    v_and_b32 v21, 0xffff0000, v20
    v_lshlrev_b32 v20, 16, v20
    v_pk_fma_f32 v[72:73], v[72:73], v[200:201], v[20:21]
    buffer_store_dword v72, v247, s[80:83], s28 offen offset:0
    buffer_store_dword v73, v247, s[80:83], s28 offen offset:2048
    v_lshlrev_b32 v22, 16, v213
    v_and_b32 v23, 0xffff0000, v213
    v_pk_add_f32 v[74:75], v[74:75], v[90:91]
    v_pk_add_f32 v[20:21], v[42:43], v[22:23]
    v_cvt_pk_bf16_f32 v20, v20, v21
    v_pk_add_f32 v[106:107], v[106:107], v[122:123]
    v_and_b32 v21, 0xffff0000, v20
    v_lshlrev_b32 v20, 16, v20
    v_pk_mul_f32 v[20:21], v[20:21], v[226:227]
    v_pk_add_f32 v[74:75], v[74:75], v[106:107]
    v_cvt_pk_bf16_f32 v20, v20, v21
    v_and_b32 v21, 0xffff0000, v20
    v_lshlrev_b32 v20, 16, v20
    v_pk_fma_f32 v[74:75], v[74:75], v[202:203], v[20:21]
    buffer_store_dword v74, v247, s[80:83], s29 offen offset:0
    buffer_store_dword v75, v247, s[80:83], s29 offen offset:2048
    v_lshlrev_b32 v22, 16, v214
    v_and_b32 v23, 0xffff0000, v214
    v_pk_add_f32 v[76:77], v[76:77], v[92:93]
    v_pk_add_f32 v[20:21], v[44:45], v[22:23]
    v_cvt_pk_bf16_f32 v20, v20, v21
    v_pk_add_f32 v[108:109], v[108:109], v[124:125]
    v_and_b32 v21, 0xffff0000, v20
    v_lshlrev_b32 v20, 16, v20
    v_pk_mul_f32 v[20:21], v[20:21], v[228:229]
    v_pk_add_f32 v[76:77], v[76:77], v[108:109]
    v_cvt_pk_bf16_f32 v20, v20, v21
    v_and_b32 v21, 0xffff0000, v20
    v_lshlrev_b32 v20, 16, v20
    v_pk_fma_f32 v[76:77], v[76:77], v[204:205], v[20:21]
    buffer_store_dword v76, v246, s[80:83], s30 offen offset:0
    buffer_store_dword v77, v246, s[80:83], s30 offen offset:2048
    v_lshlrev_b32 v22, 16, v215
    v_and_b32 v23, 0xffff0000, v215
    v_pk_add_f32 v[78:79], v[78:79], v[94:95]
    v_pk_add_f32 v[20:21], v[46:47], v[22:23]
    v_cvt_pk_bf16_f32 v20, v20, v21
    v_pk_add_f32 v[110:111], v[110:111], v[126:127]
    v_and_b32 v21, 0xffff0000, v20
    v_lshlrev_b32 v20, 16, v20
    v_pk_mul_f32 v[20:21], v[20:21], v[230:231]
    v_pk_add_f32 v[78:79], v[78:79], v[110:111]
    v_cvt_pk_bf16_f32 v20, v20, v21
    v_and_b32 v21, 0xffff0000, v20
    v_lshlrev_b32 v20, 16, v20
    v_pk_fma_f32 v[78:79], v[78:79], v[206:207], v[20:21]
    buffer_store_dword v78, v246, s[80:83], s31 offen offset:0
    buffer_store_dword v79, v246, s[80:83], s31 offen offset:2048
    s_endpgm
.section .rodata,"a"
.p2align 6
.amdhsa_kernel gated_mix__ssm_conv_s4d__ssm_conv_s5__prompt_kernel
  .amdhsa_next_free_vgpr 256
  .amdhsa_next_free_sgpr 102
  .amdhsa_accum_offset 256
  .amdhsa_group_segment_fixed_size 0
  .amdhsa_kernarg_size 160
  .amdhsa_user_sgpr_count 2
  .amdhsa_user_sgpr_kernarg_segment_ptr 1
  .amdhsa_system_sgpr_workgroup_id_x 1
.end_amdhsa_kernel
```
